```python
import torch

def _softmax(x, axis=-1):
    return torch.softmax(x, dim=axis)
def _gelu(x):
    return torch.nn.functional.gelu(x, approximate="tanh")
def _silu(x):
    return torch.nn.functional.silu(x)
def _sigmoid(x):
    return torch.sigmoid(x)
def _layernorm(x, axis=-1, eps=1e-5):
    m = x.mean(dim=axis, keepdim=True)
    v = x.var(dim=axis, keepdim=True, unbiased=False)
    return (x - m) / torch.sqrt(v + eps)
def _scatter_add(tgt, idx, src, axis=0):
    return tgt.clone().index_add_(axis, idx, src)
def _segment_sum(src, seg, n):
    out = torch.zeros((n,) + src.shape[1:], dtype=src.dtype)
    return out.index_add_(0, seg, src)
def _pad(x, pw):
    flat = tuple(v for pair in reversed(pw) for v in pair)
    return torch.nn.functional.pad(x, flat)

kernel_name = 'parallel_sum__sliding_local_dilated__mixer_token_mlp__prompt'

def setup_inputs():

    _w = (lambda a: (lambda t: t.to(torch.bfloat16) if t.is_floating_point() else t)(torch.as_tensor(a)))
    def _A_setup():
        B, S, D = 1, 2048, 512
        return {
            "x": _w((lambda *s: torch.randn(*s, dtype=torch.bfloat16) * 0.05)(B, S, D)),
            "wqkv": _w((lambda *s: torch.randn(*s, dtype=torch.bfloat16) * 0.05)(D, 3 * D)),
            "wo": _w((lambda *s: torch.randn(*s, dtype=torch.bfloat16) * 0.05)(D, D)),
        }
    _A_in = _A_setup()

    def _B_setup():
        B, S, D, F = 1, 2048, 512, 1376
        return {
            "x": _w((lambda *s: torch.randn(*s, dtype=torch.bfloat16) * 0.05)(B, S, D)),
            "w1": _w((lambda *s: torch.randn(*s, dtype=torch.bfloat16) * 1.6)(S, F) * (S ** -0.5)),
            "b1": _w((lambda *s: torch.randn(*s, dtype=torch.bfloat16) * 12.8)(F) * 0.02),
            "w2": _w((lambda *s: torch.randn(*s, dtype=torch.bfloat16) * 0.8)(F, S) * (F ** -0.5)),
            "b2": _w((lambda *s: torch.randn(*s, dtype=torch.bfloat16) * 12.8)(S) * 0.02),
        }
    _B_in = _B_setup()

    return {
        "A_x": _A_in["x"],
        "A_wqkv": _A_in["wqkv"],
        "A_wo": _A_in["wo"],
        "B_x": _B_in["x"],
        "B_w1": _B_in["w1"],
        "B_b1": _B_in["b1"],
        "B_w2": _B_in["w2"],
        "B_b2": _B_in["b2"],
    }

def reference(A_x, A_wqkv, A_wo, B_x, B_w1, B_b1, B_w2, B_b2):
    def _A_ref(x, wqkv, wo):
        B, S, D = x.shape
        H = 32; Dh = D // H
        W, dil = 8, 2
        qkv = (lambda x, *d: x.permute(*d))((x @ wqkv).reshape(B, S, 3, H, Dh), 2, 0, 3, 1, 4)
        q, k, v = qkv[0], qkv[1], qkv[2]
        scale = Dh ** -0.5
        pos = torch.arange(S)
        off = torch.arange(W) * dil
        idx = pos[:, None] - off[None, :]
        mask = idx >= 0
        idx_c = torch.where(mask, idx, 0).reshape(-1)
        kg = k[:, :, idx_c, :].reshape(B, H, S, W, Dh)
        vg = v[:, :, idx_c, :].reshape(B, H, S, W, Dh)
        logits = torch.einsum("bhsd,bhswd->bhsw", q, kg) * scale
        logits = torch.where(mask[None, None, :, :], logits, -1e9)
        attn = _softmax(logits, axis=-1)
        o = torch.einsum("bhsw,bhswd->bhsd", attn, vg)
        return (lambda x, *d: x.permute(*d))(o, 0, 2, 1, 3).reshape(B, S, D) @ wo

    def _B_ref(x, w1, b1, w2, b2):
        B, S, D = x.shape
        h = _layernorm(x, axis=-1)
        u = torch.einsum("bsd,sf->bdf", h, w1) + b1
        u = _gelu(u)
        y = torch.einsum("bdf,fs->bds", u, w2) + b2
        return (lambda x, *d: x.permute(*d))(y, 0, 2, 1)

    x = A_x
    xn = _layernorm(x, axis=-1)
    return x + _A_ref(xn, A_wqkv, A_wo) + _B_ref(xn, B_w1, B_b1, B_w2, B_b2)
```

```asm
; @launch grid=(256,1,1) block=(512,1,1) lds=163840
.amdgcn_target "amdgcn-amd-amdhsa--gfx950"
.text
.globl parallel_sum__sliding_local_dilated__mixer_token_mlp__prompt_kernel
.p2align 8
.type parallel_sum__sliding_local_dilated__mixer_token_mlp__prompt_kernel,@function
parallel_sum__sliding_local_dilated__mixer_token_mlp__prompt_kernel:
  s_cmp_ge_u32 s2, 256
  s_cbranch_scc1 K_end
  s_load_dwordx16 s[64:79], s[0:1], 0
  s_load_dwordx4 s[80:83], s[0:1], 64
  s_load_dwordx2 s[84:85], s[0:1], 80
  s_mov_b32 s5, s2
  v_and_b32 v1, 63, v0
  v_lshrrev_b32 v2, 6, v0
  s_nop 0
  v_readfirstlane_b32 s44, v2
  s_mov_b32 s55, s2
  s_nop 0
  s_and_b32 s52, s55, 7
  s_lshr_b32 s53, s55, 3
  s_lshr_b32 s45, s52, 1
  s_lshl_b32 s45, s45, 3
  s_lshr_b32 s46, s53, 2
  s_add_u32 s45, s45, s46
  s_and_b32 s46, s52, 1
  s_lshl_b32 s46, s46, 2
  s_and_b32 s47, s53, 3
  s_add_u32 s46, s46, s47
  s_lshl_b32 s49, s45, 6
  s_lshl_b32 s50, s46, 6
  s_lshr_b32 s100, s53, 3
  s_lshl_b32 s95, s100, 3
  s_add_u32 s95, s95, s52
  s_lshl_b32 s52, s52, 2
  s_add_u32 s100, s100, s52
  s_and_b32 s47, s53, 7
  s_lshl_b32 s101, s100, 6
  s_lshl_b32 s3, s47, 6
  s_cmp_lt_u32 s95, 22
  s_cselect_b32 s54, 1, 0
  s_min_u32 s48, s95, 21
  s_lshl_b32 s48, s48, 6
  s_lshl_b32 s5, s45, 3
  s_add_u32 s5, s5, s46
  s_lshl_b32 s52, s5, 3
  s_and_b32 s53, s44, 3
  s_lshl_b32 s53, s53, 1
  s_add_u32 s7, s52, s53
  s_lshl_b32 s53, s7, 10
  v_lshlrev_b32 v2, 4, v1
  v_add_u32 v5, s53, v2
  s_cmp_ge_u32 s44, 4
  s_cbranch_scc1 K_prod
  s_waitcnt lgkmcnt(0)
  s_mov_b32 s8, s64
  s_mov_b32 s9, s65
  s_mov_b32 s10, 2097152
  s_mov_b32 s11, 0x00020000
  buffer_load_dwordx4 v[160:163], v5, s[8:11], 0 offen
  buffer_load_dwordx4 v[164:167], v5, s[8:11], 0 offen offset:1024
  s_lshl_b32 s53, s7, 3
  v_mov_b32 v7, s53
  s_mul_i32 s53, s7, 1152
  v_lshlrev_b32 v21, 4, v1
  v_add_u32 v21, s53, v21
  s_mov_b32 s12, s84
  s_mov_b32 s13, s85
  s_mov_b32 s14, 2359296
  s_mov_b32 s15, 0x00020000
  s_add_u32 s16, s84, 12582912
  s_addc_u32 s17, s85, 0
  s_mov_b32 s18, 16384
  s_mov_b32 s19, 0x00020000
  s_add_u32 s40, s84, 12648448
  s_addc_u32 s41, s85, 0
  s_mov_b32 s42, 16384
  s_mov_b32 s43, 0x00020000
  s_lshr_b32 s53, s55, 3
  s_cmp_eq_u32 s44, 3
  s_cbranch_scc1 K_pfa_x
  v_min_u32 v2, 23, v1
  v_cmp_le_u32 vcc, 12, v2
  s_nop 1
  v_cndmask_b32 v3, 0, 1, vcc
  v_mul_u32_u24 v4, 12, v3
  v_sub_u32 v2, v2, v4
  s_lshl_b32 s52, s53, 1
  v_add_u32 v3, s52, v3
  v_mul_u32_u24 v6, 3072, v3
  v_lshrrev_b32 v3, 2, v2
  v_lshl_add_u32 v6, v3, 10, v6
  v_and_b32 v3, 3, v2
  v_lshl_add_u32 v6, v3, 7, v6
  s_and_b32 s52, s55, 1
  s_lshl_b32 s52, s52, 9
  v_add_u32 v6, s52, v6
  s_branch K_pfa_a
K_pfa_x:
  v_min_u32 v2, 16, v1
  s_mul_i32 s52, s53, 17
  s_and_b32 s53, s55, 6
  s_lshl_b32 s53, s53, 8
  s_add_u32 s52, s52, s53
  s_sub_u32 s52, s52, 16
  v_add_u32 v2, s52, v2
  v_max_i32 v2, 0, v2
  v_lshlrev_b32 v6, 10, v2
K_pfa_a:
  s_cmp_lt_u32 s44, 2
  s_cbranch_scc1 K_pfa_end
  s_cmp_eq_u32 s44, 3
  s_cselect_b32 s96, s64, s66
  s_cselect_b32 s97, s65, s67
  s_mov_b32 s52, 1572864
  s_cselect_b32 s98, 2097152, s52
  s_mov_b32 s99, 0x00020000
  s_mov_b32 s52, 196608
  s_cselect_b32 s53, 128, s52
  s_mov_b32 s52, 0
  buffer_load_dword v240, v6, s[96:99], s52 offen
  s_add_u32 s52, s52, s53
  buffer_load_dword v241, v6, s[96:99], s52 offen
  s_add_u32 s52, s52, s53
  buffer_load_dword v242, v6, s[96:99], s52 offen
  s_add_u32 s52, s52, s53
  buffer_load_dword v243, v6, s[96:99], s52 offen
  s_add_u32 s52, s52, s53
  buffer_load_dword v244, v6, s[96:99], s52 offen
  s_add_u32 s52, s52, s53
  buffer_load_dword v245, v6, s[96:99], s52 offen
  s_add_u32 s52, s52, s53
  buffer_load_dword v246, v6, s[96:99], s52 offen
  s_add_u32 s52, s52, s53
  buffer_load_dword v247, v6, s[96:99], s52 offen
K_pfa_end:
  s_load_dword s51, s[40:41], 0
  s_add_u32 s20, s84, 4194304
  s_addc_u32 s21, s85, 0
  s_mov_b32 s22, 2162688
  s_mov_b32 s23, 0x00020000
  s_add_u32 s24, s84, 8388608
  s_addc_u32 s25, s85, 0
  s_mov_b32 s26, 1585152
  s_mov_b32 s27, 0x00020000
  v_mov_b32 v22, 0
  v_and_b32 v2, 15, v1
  v_lshrrev_b32 v3, 4, v1
  v_lshrrev_b32 v4, 1, v2
  v_xor_b32 v4, v4, v3
  v_lshlrev_b32 v8, 7, v2
  v_lshl_add_u32 v8, v4, 4, v8
  v_xor_b32 v9, 64, v8
  v_bfe_u32 v2, v1, 2, 2
  v_lshl_add_u32 v4, v3, 3, v2
  v_lshlrev_b32 v10, 7, v4
  v_lshrrev_b32 v2, 1, v2
  v_lshlrev_b32 v2, 1, v2
  v_and_b32 v3, 1, v3
  v_lshl_add_u32 v2, v3, 2, v2
  v_bfe_u32 v3, v1, 1, 1
  s_lshl_b32 s52, s44, 1
  v_add_u32 v3, s52, v3
  v_xor_b32 v2, v2, v3
  v_lshl_add_u32 v10, v2, 4, v10
  v_and_b32 v2, 1, v1
  v_lshl_add_u32 v10, v2, 3, v10
  v_add_u32 v10, 10240, v10
  v_and_b32 v2, 15, v1
  v_cmp_eq_u32 s[56:57], 0, v2
  v_mov_b32 v14, 0x3f803f80
  v_mov_b32 v32, 0
  v_mov_b32 v33, 0
  v_mov_b32 v34, 0
  v_mov_b32 v35, 0
  v_mov_b32 v36, 0
  v_mov_b32 v37, 0
  v_mov_b32 v38, 0
  v_mov_b32 v39, 0
  v_mov_b32 v40, 0
  v_mov_b32 v41, 0
  v_mov_b32 v42, 0
  v_mov_b32 v43, 0
  v_mov_b32 v44, 0
  v_mov_b32 v45, 0
  v_mov_b32 v46, 0
  v_mov_b32 v47, 0
  v_mov_b32 v48, 0
  v_mov_b32 v49, 0
  v_mov_b32 v50, 0
  v_mov_b32 v51, 0
  v_mov_b32 v52, 0
  v_mov_b32 v53, 0
  v_mov_b32 v54, 0
  v_mov_b32 v55, 0
  v_mov_b32 v56, 0
  v_mov_b32 v57, 0
  v_mov_b32 v58, 0
  v_mov_b32 v59, 0
  v_mov_b32 v60, 0
  v_mov_b32 v61, 0
  v_mov_b32 v62, 0
  v_mov_b32 v63, 0
  v_mov_b32 v64, 0
  v_mov_b32 v65, 0
  v_mov_b32 v66, 0
  v_mov_b32 v67, 0
  v_mov_b32 v68, 0
  v_mov_b32 v69, 0
  v_mov_b32 v70, 0
  v_mov_b32 v71, 0
  v_mov_b32 v72, 0
  v_mov_b32 v73, 0
  v_mov_b32 v74, 0
  v_mov_b32 v75, 0
  v_mov_b32 v76, 0
  v_mov_b32 v77, 0
  v_mov_b32 v78, 0
  v_mov_b32 v79, 0
  v_mov_b32 v80, 0
  v_mov_b32 v81, 0
  v_mov_b32 v82, 0
  v_mov_b32 v83, 0
  v_mov_b32 v84, 0
  v_mov_b32 v85, 0
  v_mov_b32 v86, 0
  v_mov_b32 v87, 0
  v_mov_b32 v88, 0
  v_mov_b32 v89, 0
  v_mov_b32 v90, 0
  v_mov_b32 v91, 0
  s_cmp_lg_u32 s44, 0
  s_cbranch_scc1 K_xw0
  s_waitcnt vmcnt(0)
  s_branch K_xwe
K_xw0:
  s_cmp_lg_u32 s44, 1
  s_cbranch_scc1 K_xw1
  s_waitcnt vmcnt(0)
  s_branch K_xwe
K_xw1:
  s_cmp_lg_u32 s44, 2
  s_cbranch_scc1 K_xw2
  s_waitcnt vmcnt(8)
  s_branch K_xwe
K_xw2:
  s_waitcnt vmcnt(8)
K_xwe:
  s_mov_b32 s91, 0x3f803f80
  v_mov_b32 v184, 0
  v_mov_b32 v186, 0
  v_mov_b32 v185, 0
  v_mov_b32 v187, 0
  v_dot2_f32_bf16 v184, v160, s91, v184
  v_dot2_f32_bf16 v186, v160, v160, v186
  v_dot2_f32_bf16 v185, v164, s91, v185
  v_dot2_f32_bf16 v187, v164, v164, v187
  v_dot2_f32_bf16 v184, v161, s91, v184
  v_dot2_f32_bf16 v186, v161, v161, v186
  v_dot2_f32_bf16 v185, v165, s91, v185
  v_dot2_f32_bf16 v187, v165, v165, v187
  v_dot2_f32_bf16 v184, v162, s91, v184
  v_dot2_f32_bf16 v186, v162, v162, v186
  v_dot2_f32_bf16 v185, v166, s91, v185
  v_dot2_f32_bf16 v187, v166, v166, v187
  v_dot2_f32_bf16 v184, v163, s91, v184
  v_dot2_f32_bf16 v186, v163, v163, v186
  v_dot2_f32_bf16 v185, v167, s91, v185
  v_dot2_f32_bf16 v187, v167, v167, v187
  v_lshlrev_b32 v168, 16, v160
  v_and_b32 v169, 0xffff0000, v160
  v_lshlrev_b32 v170, 16, v161
  v_and_b32 v171, 0xffff0000, v161
  v_lshlrev_b32 v172, 16, v162
  v_and_b32 v173, 0xffff0000, v162
  v_lshlrev_b32 v174, 16, v163
  v_and_b32 v175, 0xffff0000, v163
  v_lshlrev_b32 v176, 16, v164
  v_and_b32 v177, 0xffff0000, v164
  v_lshlrev_b32 v178, 16, v165
  v_and_b32 v179, 0xffff0000, v165
  v_lshlrev_b32 v180, 16, v166
  v_and_b32 v181, 0xffff0000, v166
  v_lshlrev_b32 v182, 16, v167
  v_and_b32 v183, 0xffff0000, v167
  v_add_f32_dpp v184, v184, v184 quad_perm:[1,0,3,2] row_mask:0xf bank_mask:0xf
  v_add_f32_dpp v185, v185, v185 quad_perm:[1,0,3,2] row_mask:0xf bank_mask:0xf
  v_add_f32_dpp v186, v186, v186 quad_perm:[1,0,3,2] row_mask:0xf bank_mask:0xf
  v_add_f32_dpp v187, v187, v187 quad_perm:[1,0,3,2] row_mask:0xf bank_mask:0xf
  v_add_f32_dpp v184, v184, v184 quad_perm:[2,3,0,1] row_mask:0xf bank_mask:0xf
  v_add_f32_dpp v185, v185, v185 quad_perm:[2,3,0,1] row_mask:0xf bank_mask:0xf
  v_add_f32_dpp v186, v186, v186 quad_perm:[2,3,0,1] row_mask:0xf bank_mask:0xf
  v_add_f32_dpp v187, v187, v187 quad_perm:[2,3,0,1] row_mask:0xf bank_mask:0xf
  v_add_f32_dpp v184, v184, v184 row_half_mirror row_mask:0xf bank_mask:0xf
  v_add_f32_dpp v185, v185, v185 row_half_mirror row_mask:0xf bank_mask:0xf
  v_add_f32_dpp v186, v186, v186 row_half_mirror row_mask:0xf bank_mask:0xf
  v_add_f32_dpp v187, v187, v187 row_half_mirror row_mask:0xf bank_mask:0xf
  v_add_f32_dpp v184, v184, v184 row_mirror row_mask:0xf bank_mask:0xf
  v_add_f32_dpp v185, v185, v185 row_mirror row_mask:0xf bank_mask:0xf
  v_add_f32_dpp v186, v186, v186 row_mirror row_mask:0xf bank_mask:0xf
  v_add_f32_dpp v187, v187, v187 row_mirror row_mask:0xf bank_mask:0xf
  v_mov_b32 v188, v184
  v_mov_b32 v189, v185
  v_mov_b32 v190, v186
  v_mov_b32 v191, v187
  v_permlane16_swap_b32 v184, v188
  v_permlane16_swap_b32 v185, v189
  v_permlane16_swap_b32 v186, v190
  v_permlane16_swap_b32 v187, v191
  v_add_f32 v184, v184, v188
  v_add_f32 v185, v185, v189
  v_add_f32 v186, v186, v190
  v_add_f32 v187, v187, v191
  v_mov_b32 v188, v184
  v_mov_b32 v189, v185
  v_mov_b32 v190, v186
  v_mov_b32 v191, v187
  v_permlane32_swap_b32 v184, v188
  v_permlane32_swap_b32 v185, v189
  v_permlane32_swap_b32 v186, v190
  v_permlane32_swap_b32 v187, v191
  v_add_f32 v184, v184, v188
  v_add_f32 v185, v185, v189
  v_add_f32 v186, v186, v190
  v_add_f32 v187, v187, v191
  v_mul_f32 v184, 0x3b000000, v184
  v_mul_f32 v186, 0x3b000000, v186
  v_mul_f32 v185, 0x3b000000, v185
  v_mul_f32 v187, 0x3b000000, v187
  v_fma_f32 v186, -v184, v184, v186
  v_fma_f32 v187, -v185, v185, v187
  v_max_f32 v186, 0, v186
  v_max_f32 v187, 0, v187
  v_add_f32 v192, 0x3727c5ac, v186
  v_add_f32 v194, 0x3727c5ac, v187
  v_rsq_f32 v192, v192
  v_rsq_f32 v194, v194
  v_mul_f32 v193, -v184, v192
  v_mul_f32 v196, v192, v192
  v_mul_f32 v195, -v185, v194
  v_mul_f32 v197, v194, v194
  v_mov_b32 v198, 0x3727c5ac
  v_fmac_f32 v198, v196, v186
  v_mov_b32 v199, 0x3727c5ac
  v_fmac_f32 v199, v197, v187
  v_rsq_f32 v198, v198
  v_rsq_f32 v199, v199
  s_mov_b64 exec, 1
  buffer_store_dwordx4 v[192:195], v7, s[16:19], 0 offen sc1
  s_mov_b64 exec, -1
  v_mul_f32 v196, v192, v198
  v_mul_f32 v198, v193, v198
  v_mul_f32 v197, v194, v199
  v_mul_f32 v199, v195, v199
  v_fma_f32 v168, v168, v196, v198
  v_fma_f32 v169, v169, v196, v198
  v_fma_f32 v170, v170, v196, v198
  v_fma_f32 v171, v171, v196, v198
  v_fma_f32 v172, v172, v196, v198
  v_fma_f32 v173, v173, v196, v198
  v_fma_f32 v174, v174, v196, v198
  v_fma_f32 v175, v175, v196, v198
  v_fma_f32 v176, v176, v197, v199
  v_fma_f32 v177, v177, v197, v199
  v_fma_f32 v178, v178, v197, v199
  v_fma_f32 v179, v179, v197, v199
  v_fma_f32 v180, v180, v197, v199
  v_fma_f32 v181, v181, v197, v199
  v_fma_f32 v182, v182, v197, v199
  v_fma_f32 v183, v183, v197, v199
  v_cvt_pk_bf16_f32 v160, v168, v169
  v_cvt_pk_bf16_f32 v161, v170, v171
  v_cvt_pk_bf16_f32 v162, v172, v173
  v_cvt_pk_bf16_f32 v163, v174, v175
  v_cvt_pk_bf16_f32 v164, v176, v177
  v_cvt_pk_bf16_f32 v165, v178, v179
  v_cvt_pk_bf16_f32 v166, v180, v181
  v_cvt_pk_bf16_f32 v167, v182, v183
  buffer_store_dwordx4 v[160:163], v21, s[12:15], 0 offen sc1
  buffer_store_dwordx4 v[164:167], v21, s[12:15], 0 offen offset:1152 sc1
  s_waitcnt lgkmcnt(0)
  s_add_u32 s51, s51, 1
  s_lshl_b32 s94, s45, 3
  s_add_u32 s94, s94, s46
  s_barrier
  v_add_u32 v11, 0, v8
  v_add_u32 v12, 0, v9
  v_add_u32 v13, 0, v10
  ds_read_b64_tr_b16 v[116:117], v13 offset:0
  ds_read_b64_tr_b16 v[118:119], v13 offset:512
  ds_read_b64_tr_b16 v[120:121], v13 offset:8192
  ds_read_b64_tr_b16 v[122:123], v13 offset:8704
  ds_read_b64_tr_b16 v[124:125], v13 offset:16384
  ds_read_b64_tr_b16 v[126:127], v13 offset:16896
  ds_read_b128 v[96:99], v11 offset:0
  ds_read_b128 v[100:103], v11 offset:2048
  ds_read_b128 v[104:107], v11 offset:4096
  ds_read_b128 v[108:111], v11 offset:6144
  ds_read_b128 v[112:115], v11 offset:8192
  ds_read_b64_tr_b16 v[148:149], v13 offset:4096
  ds_read_b64_tr_b16 v[150:151], v13 offset:4608
  ds_read_b64_tr_b16 v[152:153], v13 offset:12288
  ds_read_b64_tr_b16 v[154:155], v13 offset:12800
  ds_read_b64_tr_b16 v[156:157], v13 offset:20480
  ds_read_b64_tr_b16 v[158:159], v13 offset:20992
  ds_read_b128 v[128:131], v12 offset:0
  ds_read_b128 v[132:135], v12 offset:2048
  ds_read_b128 v[136:139], v12 offset:4096
  ds_read_b128 v[140:143], v12 offset:6144
  ds_read_b128 v[144:147], v12 offset:8192
  s_waitcnt vmcnt(0)
  s_waitcnt lgkmcnt(0)
  s_barrier
  s_cmp_lg_u32 s44, 0
  s_cbranch_scc1 K_post1000
  s_lshl_b32 s52, s5, 2
  s_add_u32 s52, s52, 4096
  v_mov_b32 v2, s52
  v_mov_b32 v3, s51
  s_mov_b64 exec, 1
  buffer_store_dword v3, v2, s[40:43], 0 offen sc1
  s_mov_b64 exec, -1
K_post1000:
  v_add_u32 v11, 34816, v8
  v_add_u32 v12, 34816, v9
  v_add_u32 v13, 34816, v10
  v_cndmask_b32 v96, v96, v14, s[56:57]
  v_cndmask_b32 v97, v97, v14, s[56:57]
  v_cndmask_b32 v98, v98, v14, s[56:57]
  v_cndmask_b32 v99, v99, v14, s[56:57]
  v_cndmask_b32 v128, v128, v14, s[56:57]
  v_cndmask_b32 v129, v129, v14, s[56:57]
  v_cndmask_b32 v130, v130, v14, s[56:57]
  v_cndmask_b32 v131, v131, v14, s[56:57]
  v_mfma_f32_16x16x32_bf16 v[36:39], v[116:119], v[100:103], v[36:39]
  ds_read_b64_tr_b16 v[180:181], v13 offset:0
  v_mfma_f32_16x16x32_bf16 v[56:59], v[120:123], v[100:103], v[56:59]
  ds_read_b64_tr_b16 v[182:183], v13 offset:512
  v_mfma_f32_16x16x32_bf16 v[76:79], v[100:103], v[124:127], v[76:79]
  ds_read_b64_tr_b16 v[184:185], v13 offset:8192
  v_mfma_f32_16x16x32_bf16 v[40:43], v[116:119], v[104:107], v[40:43]
  ds_read_b64_tr_b16 v[186:187], v13 offset:8704
  v_mfma_f32_16x16x32_bf16 v[60:63], v[120:123], v[104:107], v[60:63]
  ds_read_b64_tr_b16 v[188:189], v13 offset:16384
  v_mfma_f32_16x16x32_bf16 v[80:83], v[104:107], v[124:127], v[80:83]
  ds_read_b64_tr_b16 v[190:191], v13 offset:16896
  v_mfma_f32_16x16x32_bf16 v[44:47], v[116:119], v[108:111], v[44:47]
  ds_read_b128 v[160:163], v11 offset:0
  v_mfma_f32_16x16x32_bf16 v[64:67], v[120:123], v[108:111], v[64:67]
  ds_read_b128 v[164:167], v11 offset:2048
  v_mfma_f32_16x16x32_bf16 v[84:87], v[108:111], v[124:127], v[84:87]
  ds_read_b128 v[168:171], v11 offset:4096
  v_mfma_f32_16x16x32_bf16 v[48:51], v[116:119], v[112:115], v[48:51]
  ds_read_b128 v[172:175], v11 offset:6144
  v_mfma_f32_16x16x32_bf16 v[68:71], v[120:123], v[112:115], v[68:71]
  ds_read_b128 v[176:179], v11 offset:8192
  v_mfma_f32_16x16x32_bf16 v[88:91], v[112:115], v[124:127], v[88:91]
  ds_read_b64_tr_b16 v[212:213], v13 offset:4096
  v_mfma_f32_16x16x32_bf16 v[32:35], v[116:119], v[96:99], v[32:35]
  ds_read_b64_tr_b16 v[214:215], v13 offset:4608
  v_mfma_f32_16x16x32_bf16 v[52:55], v[120:123], v[96:99], v[52:55]
  ds_read_b64_tr_b16 v[216:217], v13 offset:12288
  v_mfma_f32_16x16x32_bf16 v[72:75], v[96:99], v[124:127], v[72:75]
  ds_read_b64_tr_b16 v[218:219], v13 offset:12800
  v_mfma_f32_16x16x32_bf16 v[36:39], v[148:151], v[132:135], v[36:39]
  ds_read_b64_tr_b16 v[220:221], v13 offset:20480
  v_mfma_f32_16x16x32_bf16 v[56:59], v[152:155], v[132:135], v[56:59]
  ds_read_b64_tr_b16 v[222:223], v13 offset:20992
  v_mfma_f32_16x16x32_bf16 v[76:79], v[132:135], v[156:159], v[76:79]
  ds_read_b128 v[192:195], v12 offset:0
  v_mfma_f32_16x16x32_bf16 v[40:43], v[148:151], v[136:139], v[40:43]
  ds_read_b128 v[196:199], v12 offset:2048
  v_mfma_f32_16x16x32_bf16 v[60:63], v[152:155], v[136:139], v[60:63]
  ds_read_b128 v[200:203], v12 offset:4096
  v_mfma_f32_16x16x32_bf16 v[80:83], v[136:139], v[156:159], v[80:83]
  ds_read_b128 v[204:207], v12 offset:6144
  v_mfma_f32_16x16x32_bf16 v[44:47], v[148:151], v[140:143], v[44:47]
  ds_read_b128 v[208:211], v12 offset:8192
  v_mfma_f32_16x16x32_bf16 v[64:67], v[152:155], v[140:143], v[64:67]
  v_mfma_f32_16x16x32_bf16 v[84:87], v[140:143], v[156:159], v[84:87]
  v_mfma_f32_16x16x32_bf16 v[48:51], v[148:151], v[144:147], v[48:51]
  v_mfma_f32_16x16x32_bf16 v[68:71], v[152:155], v[144:147], v[68:71]
  v_mfma_f32_16x16x32_bf16 v[88:91], v[144:147], v[156:159], v[88:91]
  v_mfma_f32_16x16x32_bf16 v[32:35], v[148:151], v[128:131], v[32:35]
  v_mfma_f32_16x16x32_bf16 v[52:55], v[152:155], v[128:131], v[52:55]
  v_mfma_f32_16x16x32_bf16 v[72:75], v[128:131], v[156:159], v[72:75]
  s_waitcnt lgkmcnt(0)
  s_barrier
  v_add_u32 v11, 69632, v8
  v_add_u32 v12, 69632, v9
  v_add_u32 v13, 69632, v10
  v_cndmask_b32 v160, v160, v14, s[56:57]
  v_cndmask_b32 v161, v161, v14, s[56:57]
  v_cndmask_b32 v162, v162, v14, s[56:57]
  v_cndmask_b32 v163, v163, v14, s[56:57]
  v_cndmask_b32 v192, v192, v14, s[56:57]
  v_cndmask_b32 v193, v193, v14, s[56:57]
  v_cndmask_b32 v194, v194, v14, s[56:57]
  v_cndmask_b32 v195, v195, v14, s[56:57]
  v_mfma_f32_16x16x32_bf16 v[36:39], v[180:183], v[164:167], v[36:39]
  ds_read_b64_tr_b16 v[116:117], v13 offset:0
  v_mfma_f32_16x16x32_bf16 v[56:59], v[184:187], v[164:167], v[56:59]
  ds_read_b64_tr_b16 v[118:119], v13 offset:512
  v_mfma_f32_16x16x32_bf16 v[76:79], v[164:167], v[188:191], v[76:79]
  ds_read_b64_tr_b16 v[120:121], v13 offset:8192
  v_mfma_f32_16x16x32_bf16 v[40:43], v[180:183], v[168:171], v[40:43]
  ds_read_b64_tr_b16 v[122:123], v13 offset:8704
  v_mfma_f32_16x16x32_bf16 v[60:63], v[184:187], v[168:171], v[60:63]
  ds_read_b64_tr_b16 v[124:125], v13 offset:16384
  v_mfma_f32_16x16x32_bf16 v[80:83], v[168:171], v[188:191], v[80:83]
  ds_read_b64_tr_b16 v[126:127], v13 offset:16896
  v_mfma_f32_16x16x32_bf16 v[44:47], v[180:183], v[172:175], v[44:47]
  ds_read_b128 v[96:99], v11 offset:0
  v_mfma_f32_16x16x32_bf16 v[64:67], v[184:187], v[172:175], v[64:67]
  ds_read_b128 v[100:103], v11 offset:2048
  v_mfma_f32_16x16x32_bf16 v[84:87], v[172:175], v[188:191], v[84:87]
  ds_read_b128 v[104:107], v11 offset:4096
  v_mfma_f32_16x16x32_bf16 v[48:51], v[180:183], v[176:179], v[48:51]
  ds_read_b128 v[108:111], v11 offset:6144
  v_mfma_f32_16x16x32_bf16 v[68:71], v[184:187], v[176:179], v[68:71]
  ds_read_b128 v[112:115], v11 offset:8192
  v_mfma_f32_16x16x32_bf16 v[88:91], v[176:179], v[188:191], v[88:91]
  ds_read_b64_tr_b16 v[148:149], v13 offset:4096
  v_mfma_f32_16x16x32_bf16 v[32:35], v[180:183], v[160:163], v[32:35]
  ds_read_b64_tr_b16 v[150:151], v13 offset:4608
  v_mfma_f32_16x16x32_bf16 v[52:55], v[184:187], v[160:163], v[52:55]
  ds_read_b64_tr_b16 v[152:153], v13 offset:12288
  v_mfma_f32_16x16x32_bf16 v[72:75], v[160:163], v[188:191], v[72:75]
  ds_read_b64_tr_b16 v[154:155], v13 offset:12800
  v_mfma_f32_16x16x32_bf16 v[36:39], v[212:215], v[196:199], v[36:39]
  ds_read_b64_tr_b16 v[156:157], v13 offset:20480
  v_mfma_f32_16x16x32_bf16 v[56:59], v[216:219], v[196:199], v[56:59]
  ds_read_b64_tr_b16 v[158:159], v13 offset:20992
  v_mfma_f32_16x16x32_bf16 v[76:79], v[196:199], v[220:223], v[76:79]
  ds_read_b128 v[128:131], v12 offset:0
  v_mfma_f32_16x16x32_bf16 v[40:43], v[212:215], v[200:203], v[40:43]
  ds_read_b128 v[132:135], v12 offset:2048
  v_mfma_f32_16x16x32_bf16 v[60:63], v[216:219], v[200:203], v[60:63]
  ds_read_b128 v[136:139], v12 offset:4096
  v_mfma_f32_16x16x32_bf16 v[80:83], v[200:203], v[220:223], v[80:83]
  ds_read_b128 v[140:143], v12 offset:6144
  v_mfma_f32_16x16x32_bf16 v[44:47], v[212:215], v[204:207], v[44:47]
  ds_read_b128 v[144:147], v12 offset:8192
  v_mfma_f32_16x16x32_bf16 v[64:67], v[216:219], v[204:207], v[64:67]
  v_mfma_f32_16x16x32_bf16 v[84:87], v[204:207], v[220:223], v[84:87]
  v_mfma_f32_16x16x32_bf16 v[48:51], v[212:215], v[208:211], v[48:51]
  v_mfma_f32_16x16x32_bf16 v[68:71], v[216:219], v[208:211], v[68:71]
  v_mfma_f32_16x16x32_bf16 v[88:91], v[208:211], v[220:223], v[88:91]
  v_mfma_f32_16x16x32_bf16 v[32:35], v[212:215], v[192:195], v[32:35]
  v_mfma_f32_16x16x32_bf16 v[52:55], v[216:219], v[192:195], v[52:55]
  v_mfma_f32_16x16x32_bf16 v[72:75], v[192:195], v[220:223], v[72:75]
  s_waitcnt lgkmcnt(0)
  s_barrier
  v_add_u32 v11, 104448, v8
  v_add_u32 v12, 104448, v9
  v_add_u32 v13, 104448, v10
  v_cndmask_b32 v96, v96, v14, s[56:57]
  v_cndmask_b32 v97, v97, v14, s[56:57]
  v_cndmask_b32 v98, v98, v14, s[56:57]
  v_cndmask_b32 v99, v99, v14, s[56:57]
  v_cndmask_b32 v128, v128, v14, s[56:57]
  v_cndmask_b32 v129, v129, v14, s[56:57]
  v_cndmask_b32 v130, v130, v14, s[56:57]
  v_cndmask_b32 v131, v131, v14, s[56:57]
  v_mfma_f32_16x16x32_bf16 v[36:39], v[116:119], v[100:103], v[36:39]
  ds_read_b64_tr_b16 v[180:181], v13 offset:0
  v_mfma_f32_16x16x32_bf16 v[56:59], v[120:123], v[100:103], v[56:59]
  ds_read_b64_tr_b16 v[182:183], v13 offset:512
  v_mfma_f32_16x16x32_bf16 v[76:79], v[100:103], v[124:127], v[76:79]
  ds_read_b64_tr_b16 v[184:185], v13 offset:8192
  v_mfma_f32_16x16x32_bf16 v[40:43], v[116:119], v[104:107], v[40:43]
  ds_read_b64_tr_b16 v[186:187], v13 offset:8704
  v_mfma_f32_16x16x32_bf16 v[60:63], v[120:123], v[104:107], v[60:63]
  ds_read_b64_tr_b16 v[188:189], v13 offset:16384
  v_mfma_f32_16x16x32_bf16 v[80:83], v[104:107], v[124:127], v[80:83]
  ds_read_b64_tr_b16 v[190:191], v13 offset:16896
  v_mfma_f32_16x16x32_bf16 v[44:47], v[116:119], v[108:111], v[44:47]
  ds_read_b128 v[160:163], v11 offset:0
  v_mfma_f32_16x16x32_bf16 v[64:67], v[120:123], v[108:111], v[64:67]
  ds_read_b128 v[164:167], v11 offset:2048
  v_mfma_f32_16x16x32_bf16 v[84:87], v[108:111], v[124:127], v[84:87]
  ds_read_b128 v[168:171], v11 offset:4096
  v_mfma_f32_16x16x32_bf16 v[48:51], v[116:119], v[112:115], v[48:51]
  ds_read_b128 v[172:175], v11 offset:6144
  v_mfma_f32_16x16x32_bf16 v[68:71], v[120:123], v[112:115], v[68:71]
  ds_read_b128 v[176:179], v11 offset:8192
  v_mfma_f32_16x16x32_bf16 v[88:91], v[112:115], v[124:127], v[88:91]
  ds_read_b64_tr_b16 v[212:213], v13 offset:4096
  v_mfma_f32_16x16x32_bf16 v[32:35], v[116:119], v[96:99], v[32:35]
  ds_read_b64_tr_b16 v[214:215], v13 offset:4608
  v_mfma_f32_16x16x32_bf16 v[52:55], v[120:123], v[96:99], v[52:55]
  ds_read_b64_tr_b16 v[216:217], v13 offset:12288
  v_mfma_f32_16x16x32_bf16 v[72:75], v[96:99], v[124:127], v[72:75]
  ds_read_b64_tr_b16 v[218:219], v13 offset:12800
  v_mfma_f32_16x16x32_bf16 v[36:39], v[148:151], v[132:135], v[36:39]
  ds_read_b64_tr_b16 v[220:221], v13 offset:20480
  v_mfma_f32_16x16x32_bf16 v[56:59], v[152:155], v[132:135], v[56:59]
  ds_read_b64_tr_b16 v[222:223], v13 offset:20992
  v_mfma_f32_16x16x32_bf16 v[76:79], v[132:135], v[156:159], v[76:79]
  ds_read_b128 v[192:195], v12 offset:0
  v_mfma_f32_16x16x32_bf16 v[40:43], v[148:151], v[136:139], v[40:43]
  ds_read_b128 v[196:199], v12 offset:2048
  v_mfma_f32_16x16x32_bf16 v[60:63], v[152:155], v[136:139], v[60:63]
  ds_read_b128 v[200:203], v12 offset:4096
  v_mfma_f32_16x16x32_bf16 v[80:83], v[136:139], v[156:159], v[80:83]
  ds_read_b128 v[204:207], v12 offset:6144
  v_mfma_f32_16x16x32_bf16 v[44:47], v[148:151], v[140:143], v[44:47]
  ds_read_b128 v[208:211], v12 offset:8192
  v_mfma_f32_16x16x32_bf16 v[64:67], v[152:155], v[140:143], v[64:67]
  v_mfma_f32_16x16x32_bf16 v[84:87], v[140:143], v[156:159], v[84:87]
  v_mfma_f32_16x16x32_bf16 v[48:51], v[148:151], v[144:147], v[48:51]
  v_mfma_f32_16x16x32_bf16 v[68:71], v[152:155], v[144:147], v[68:71]
  v_mfma_f32_16x16x32_bf16 v[88:91], v[144:147], v[156:159], v[88:91]
  v_mfma_f32_16x16x32_bf16 v[32:35], v[148:151], v[128:131], v[32:35]
  v_mfma_f32_16x16x32_bf16 v[52:55], v[152:155], v[128:131], v[52:55]
  v_mfma_f32_16x16x32_bf16 v[72:75], v[128:131], v[156:159], v[72:75]
  s_mul_i32 s52, s44, 2304
  s_add_u32 s52, s52, 154624
  v_and_b32 v2, 15, v1
  v_mul_u32_u24 v20, 144, v2
  v_lshrrev_b32 v3, 4, v1
  v_lshl_add_u32 v20, v3, 3, v20
  v_add_u32 v20, s52, v20
  v_lshrrev_b32 v2, 3, v1
  v_mul_u32_u24 v21, 144, v2
  v_and_b32 v4, 7, v1
  v_lshl_add_u32 v21, v4, 4, v21
  v_add_u32 v21, s52, v21
  s_lshl_b32 s53, s44, 4
  s_add_u32 s52, s50, s53
  v_add_u32 v2, s52, v2
  v_mul_u32_u24 v15, 4224, v2
  v_lshl_add_u32 v15, v4, 4, v15
  s_lshl_b32 s52, s49, 1
  v_add_u32 v15, s52, v15
  v_and_b32 v2, 15, v1
  v_and_b32 v4, 1, v1
  v_cmp_eq_u32 s[58:59], 1, v4
  v_lshl_add_u32 v3, v3, 2, v4
  v_cmp_gt_u32 s[86:87], v3, v2
  v_add_u32 v3, 2, v3
  v_cmp_gt_u32 s[88:89], v3, v2
  v_mov_b32 v2, 0x0c0c0100
  v_mov_b32 v3, 0x01000c0c
  v_cndmask_b32 v2, v2, v3, s[58:59]
  v_mov_b32 v4, 0x0c0c0c0c
  v_cndmask_b32 v16, v4, v2, s[86:87]
  v_cndmask_b32 v18, v2, v4, s[86:87]
  v_mov_b32 v2, 0x0c0c0302
  v_mov_b32 v3, 0x03020c0c
  v_cndmask_b32 v2, v2, v3, s[58:59]
  v_cndmask_b32 v17, v4, v2, s[88:89]
  v_cndmask_b32 v19, v2, v4, s[88:89]
  s_cmp_eq_u32 s45, 0
  s_cselect_b32 s90, 0xf149f2ca, 0
  s_waitcnt lgkmcnt(0)
  s_barrier
  v_add_u32 v11, 0, v8
  v_add_u32 v12, 0, v9
  v_add_u32 v13, 0, v10
  v_cndmask_b32 v160, v160, v14, s[56:57]
  v_cndmask_b32 v161, v161, v14, s[56:57]
  v_cndmask_b32 v162, v162, v14, s[56:57]
  v_cndmask_b32 v163, v163, v14, s[56:57]
  v_cndmask_b32 v192, v192, v14, s[56:57]
  v_cndmask_b32 v193, v193, v14, s[56:57]
  v_cndmask_b32 v194, v194, v14, s[56:57]
  v_cndmask_b32 v195, v195, v14, s[56:57]
  v_mfma_f32_16x16x32_bf16 v[36:39], v[180:183], v[164:167], v[36:39]
  ds_read_b64_tr_b16 v[116:117], v13 offset:0
  v_mfma_f32_16x16x32_bf16 v[56:59], v[184:187], v[164:167], v[56:59]
  ds_read_b64_tr_b16 v[118:119], v13 offset:512
  v_mfma_f32_16x16x32_bf16 v[76:79], v[164:167], v[188:191], v[76:79]
  ds_read_b64_tr_b16 v[120:121], v13 offset:8192
  v_mfma_f32_16x16x32_bf16 v[40:43], v[180:183], v[168:171], v[40:43]
  ds_read_b64_tr_b16 v[122:123], v13 offset:8704
  v_mfma_f32_16x16x32_bf16 v[60:63], v[184:187], v[168:171], v[60:63]
  ds_read_b64_tr_b16 v[124:125], v13 offset:16384
  v_mfma_f32_16x16x32_bf16 v[80:83], v[168:171], v[188:191], v[80:83]
  ds_read_b64_tr_b16 v[126:127], v13 offset:16896
  v_mfma_f32_16x16x32_bf16 v[44:47], v[180:183], v[172:175], v[44:47]
  ds_read_b128 v[96:99], v11 offset:0
  v_mfma_f32_16x16x32_bf16 v[64:67], v[184:187], v[172:175], v[64:67]
  ds_read_b128 v[100:103], v11 offset:2048
  v_mfma_f32_16x16x32_bf16 v[84:87], v[172:175], v[188:191], v[84:87]
  ds_read_b128 v[104:107], v11 offset:4096
  v_mfma_f32_16x16x32_bf16 v[48:51], v[180:183], v[176:179], v[48:51]
  ds_read_b128 v[108:111], v11 offset:6144
  v_mfma_f32_16x16x32_bf16 v[68:71], v[184:187], v[176:179], v[68:71]
  ds_read_b128 v[112:115], v11 offset:8192
  v_mfma_f32_16x16x32_bf16 v[88:91], v[176:179], v[188:191], v[88:91]
  ds_read_b64_tr_b16 v[148:149], v13 offset:4096
  v_mfma_f32_16x16x32_bf16 v[32:35], v[180:183], v[160:163], v[32:35]
  ds_read_b64_tr_b16 v[150:151], v13 offset:4608
  v_mfma_f32_16x16x32_bf16 v[52:55], v[184:187], v[160:163], v[52:55]
  ds_read_b64_tr_b16 v[152:153], v13 offset:12288
  v_mfma_f32_16x16x32_bf16 v[72:75], v[160:163], v[188:191], v[72:75]
  ds_read_b64_tr_b16 v[154:155], v13 offset:12800
  v_mfma_f32_16x16x32_bf16 v[36:39], v[212:215], v[196:199], v[36:39]
  ds_read_b64_tr_b16 v[156:157], v13 offset:20480
  v_mfma_f32_16x16x32_bf16 v[56:59], v[216:219], v[196:199], v[56:59]
  ds_read_b64_tr_b16 v[158:159], v13 offset:20992
  v_mfma_f32_16x16x32_bf16 v[76:79], v[196:199], v[220:223], v[76:79]
  ds_read_b128 v[128:131], v12 offset:0
  v_mfma_f32_16x16x32_bf16 v[40:43], v[212:215], v[200:203], v[40:43]
  ds_read_b128 v[132:135], v12 offset:2048
  v_mfma_f32_16x16x32_bf16 v[60:63], v[216:219], v[200:203], v[60:63]
  ds_read_b128 v[136:139], v12 offset:4096
  v_mfma_f32_16x16x32_bf16 v[80:83], v[200:203], v[220:223], v[80:83]
  ds_read_b128 v[140:143], v12 offset:6144
  v_mfma_f32_16x16x32_bf16 v[44:47], v[212:215], v[204:207], v[44:47]
  ds_read_b128 v[144:147], v12 offset:8192
  v_mfma_f32_16x16x32_bf16 v[64:67], v[216:219], v[204:207], v[64:67]
  v_mfma_f32_16x16x32_bf16 v[84:87], v[204:207], v[220:223], v[84:87]
  v_mfma_f32_16x16x32_bf16 v[48:51], v[212:215], v[208:211], v[48:51]
  v_mfma_f32_16x16x32_bf16 v[68:71], v[216:219], v[208:211], v[68:71]
  v_mfma_f32_16x16x32_bf16 v[88:91], v[208:211], v[220:223], v[88:91]
  v_mfma_f32_16x16x32_bf16 v[32:35], v[212:215], v[192:195], v[32:35]
  v_mfma_f32_16x16x32_bf16 v[52:55], v[216:219], v[192:195], v[52:55]
  v_mfma_f32_16x16x32_bf16 v[72:75], v[192:195], v[220:223], v[72:75]
  s_mov_b32 s28, s74
  s_mov_b32 s29, s75
  s_mov_b32 s30, 2752
  s_mov_b32 s31, 0x00020000
  v_lshrrev_b32 v2, 2, v1
  v_lshlrev_b32 v28, 7, v2
  v_bfe_u32 v4, v2, 1, 2
  v_lshlrev_b32 v4, 1, v4
  v_bfe_u32 v2, v1, 1, 1
  v_and_b32 v3, 1, v1
  v_lshl_add_u32 v28, v3, 3, v28
  s_lshl_b32 s52, s44, 1
  v_add_u32 v3, s52, v2
  v_xor_b32 v3, v3, v4
  v_lshl_add_u32 v29, v3, 4, v28
  v_xor_b32 v2, v2, v4
  v_lshl_add_u32 v28, v2, 4, v28
  v_and_b32 v2, 15, v1
  s_lshl_b32 s52, s44, 4
  s_add_u32 s52, s52, s48
  v_add_u32 v2, s52, v2
  v_lshlrev_b32 v31, 1, v2
  v_lshrrev_b32 v2, 3, v1
  v_add_u32 v2, s52, v2
  v_mul_u32_u24 v30, 1152, v2
  v_and_b32 v3, 7, v1
  v_lshl_add_u32 v30, v3, 4, v30
  s_lshl_b32 s52, s3, 1
  v_add_u32 v30, s52, v30
  buffer_load_ushort v31, v31, s[28:31], 0 offen
  s_cmp_eq_u32 s54, 0
  s_cbranch_scc1 K_notouch
  buffer_load_dword v6, v30, s[24:27], 0 offen
  v_add_u32 v2, 9216, v30
  buffer_load_dword v6, v2, s[24:27], 0 offen
K_notouch:
  v_mov_b32 v232, 0
  v_mov_b32 v233, 0
  v_mov_b32 v234, 0
  v_mov_b32 v235, 0
  v_mov_b32 v236, 0
  v_mov_b32 v237, 0
  v_mov_b32 v238, 0
  v_mov_b32 v239, 0
  v_mov_b32 v240, 0
  v_mov_b32 v241, 0
  v_mov_b32 v242, 0
  v_mov_b32 v243, 0
  v_mov_b32 v244, 0
  v_mov_b32 v245, 0
  v_mov_b32 v246, 0
  v_mov_b32 v247, 0
  s_waitcnt lgkmcnt(0)
  s_barrier
  s_cmp_lg_u32 s44, 1
  s_cbranch_scc1 K_piH
  v_lshlrev_b32 v22, 4, v1
  v_add_u32 v22, 4096, v22
  buffer_load_dwordx4 v[24:27], v22, s[40:43], 0 offen sc1
K_piH:
  v_add_u32 v11, 34816, v8
  v_add_u32 v12, 34816, v9
  v_add_u32 v13, 34816, v10
  v_cndmask_b32 v96, v96, v14, s[56:57]
  v_cndmask_b32 v97, v97, v14, s[56:57]
  v_cndmask_b32 v98, v98, v14, s[56:57]
  v_cndmask_b32 v99, v99, v14, s[56:57]
  v_cndmask_b32 v128, v128, v14, s[56:57]
  v_cndmask_b32 v129, v129, v14, s[56:57]
  v_cndmask_b32 v130, v130, v14, s[56:57]
  v_cndmask_b32 v131, v131, v14, s[56:57]
  v_mfma_f32_16x16x32_bf16 v[36:39], v[116:119], v[100:103], v[36:39]
  ds_read_b64_tr_b16 v[180:181], v13 offset:0
  v_mfma_f32_16x16x32_bf16 v[56:59], v[120:123], v[100:103], v[56:59]
  ds_read_b64_tr_b16 v[182:183], v13 offset:512
  v_mfma_f32_16x16x32_bf16 v[76:79], v[100:103], v[124:127], v[76:79]
  ds_read_b64_tr_b16 v[184:185], v13 offset:8192
  v_mfma_f32_16x16x32_bf16 v[40:43], v[116:119], v[104:107], v[40:43]
  ds_read_b64_tr_b16 v[186:187], v13 offset:8704
  v_mfma_f32_16x16x32_bf16 v[60:63], v[120:123], v[104:107], v[60:63]
  ds_read_b64_tr_b16 v[188:189], v13 offset:16384
  v_mfma_f32_16x16x32_bf16 v[80:83], v[104:107], v[124:127], v[80:83]
  ds_read_b64_tr_b16 v[190:191], v13 offset:16896
  v_mfma_f32_16x16x32_bf16 v[44:47], v[116:119], v[108:111], v[44:47]
  ds_read_b128 v[160:163], v11 offset:0
  v_mfma_f32_16x16x32_bf16 v[64:67], v[120:123], v[108:111], v[64:67]
  ds_read_b128 v[164:167], v11 offset:2048
  v_mfma_f32_16x16x32_bf16 v[84:87], v[108:111], v[124:127], v[84:87]
  ds_read_b128 v[168:171], v11 offset:4096
  v_mfma_f32_16x16x32_bf16 v[48:51], v[116:119], v[112:115], v[48:51]
  ds_read_b128 v[172:175], v11 offset:6144
  v_mfma_f32_16x16x32_bf16 v[68:71], v[120:123], v[112:115], v[68:71]
  ds_read_b128 v[176:179], v11 offset:8192
  v_mfma_f32_16x16x32_bf16 v[88:91], v[112:115], v[124:127], v[88:91]
  ds_read_b64_tr_b16 v[212:213], v13 offset:4096
  v_mfma_f32_16x16x32_bf16 v[32:35], v[116:119], v[96:99], v[32:35]
  ds_read_b64_tr_b16 v[214:215], v13 offset:4608
  v_mfma_f32_16x16x32_bf16 v[52:55], v[120:123], v[96:99], v[52:55]
  ds_read_b64_tr_b16 v[216:217], v13 offset:12288
  v_mfma_f32_16x16x32_bf16 v[72:75], v[96:99], v[124:127], v[72:75]
  ds_read_b64_tr_b16 v[218:219], v13 offset:12800
  v_mfma_f32_16x16x32_bf16 v[36:39], v[148:151], v[132:135], v[36:39]
  ds_read_b64_tr_b16 v[220:221], v13 offset:20480
  v_mfma_f32_16x16x32_bf16 v[56:59], v[152:155], v[132:135], v[56:59]
  ds_read_b64_tr_b16 v[222:223], v13 offset:20992
  v_mfma_f32_16x16x32_bf16 v[76:79], v[132:135], v[156:159], v[76:79]
  ds_read_b128 v[192:195], v12 offset:0
  v_mfma_f32_16x16x32_bf16 v[40:43], v[148:151], v[136:139], v[40:43]
  ds_read_b128 v[196:199], v12 offset:2048
  v_mfma_f32_16x16x32_bf16 v[60:63], v[152:155], v[136:139], v[60:63]
  ds_read_b128 v[200:203], v12 offset:4096
  v_mfma_f32_16x16x32_bf16 v[80:83], v[136:139], v[156:159], v[80:83]
  ds_read_b128 v[204:207], v12 offset:6144
  v_mfma_f32_16x16x32_bf16 v[44:47], v[148:151], v[140:143], v[44:47]
  ds_read_b128 v[208:211], v12 offset:8192
  v_mfma_f32_16x16x32_bf16 v[64:67], v[152:155], v[140:143], v[64:67]
  v_mfma_f32_16x16x32_bf16 v[84:87], v[140:143], v[156:159], v[84:87]
  v_mfma_f32_16x16x32_bf16 v[48:51], v[148:151], v[144:147], v[48:51]
  v_mfma_f32_16x16x32_bf16 v[68:71], v[152:155], v[144:147], v[68:71]
  v_mfma_f32_16x16x32_bf16 v[88:91], v[144:147], v[156:159], v[88:91]
  v_mfma_f32_16x16x32_bf16 v[32:35], v[148:151], v[128:131], v[32:35]
  v_mfma_f32_16x16x32_bf16 v[52:55], v[152:155], v[128:131], v[52:55]
  v_mfma_f32_16x16x32_bf16 v[72:75], v[128:131], v[156:159], v[72:75]
  s_waitcnt lgkmcnt(0)
  s_barrier
  v_add_u32 v11, 69632, v8
  v_add_u32 v12, 69632, v9
  v_add_u32 v13, 69632, v10
  v_cndmask_b32 v160, v160, v14, s[56:57]
  v_cndmask_b32 v161, v161, v14, s[56:57]
  v_cndmask_b32 v162, v162, v14, s[56:57]
  v_cndmask_b32 v163, v163, v14, s[56:57]
  v_cndmask_b32 v192, v192, v14, s[56:57]
  v_cndmask_b32 v193, v193, v14, s[56:57]
  v_cndmask_b32 v194, v194, v14, s[56:57]
  v_cndmask_b32 v195, v195, v14, s[56:57]
  v_mfma_f32_16x16x32_bf16 v[36:39], v[180:183], v[164:167], v[36:39]
  ds_read_b64_tr_b16 v[116:117], v13 offset:0
  v_mfma_f32_16x16x32_bf16 v[56:59], v[184:187], v[164:167], v[56:59]
  ds_read_b64_tr_b16 v[118:119], v13 offset:512
  v_mfma_f32_16x16x32_bf16 v[76:79], v[164:167], v[188:191], v[76:79]
  ds_read_b64_tr_b16 v[120:121], v13 offset:8192
  v_mfma_f32_16x16x32_bf16 v[40:43], v[180:183], v[168:171], v[40:43]
  ds_read_b64_tr_b16 v[122:123], v13 offset:8704
  v_mfma_f32_16x16x32_bf16 v[60:63], v[184:187], v[168:171], v[60:63]
  ds_read_b64_tr_b16 v[124:125], v13 offset:16384
  v_mfma_f32_16x16x32_bf16 v[80:83], v[168:171], v[188:191], v[80:83]
  ds_read_b64_tr_b16 v[126:127], v13 offset:16896
  v_mfma_f32_16x16x32_bf16 v[44:47], v[180:183], v[172:175], v[44:47]
  ds_read_b128 v[96:99], v11 offset:0
  v_mfma_f32_16x16x32_bf16 v[64:67], v[184:187], v[172:175], v[64:67]
  ds_read_b128 v[100:103], v11 offset:2048
  v_mfma_f32_16x16x32_bf16 v[84:87], v[172:175], v[188:191], v[84:87]
  ds_read_b128 v[104:107], v11 offset:4096
  v_mfma_f32_16x16x32_bf16 v[48:51], v[180:183], v[176:179], v[48:51]
  ds_read_b128 v[108:111], v11 offset:6144
  v_mfma_f32_16x16x32_bf16 v[68:71], v[184:187], v[176:179], v[68:71]
  ds_read_b128 v[112:115], v11 offset:8192
  v_mfma_f32_16x16x32_bf16 v[88:91], v[176:179], v[188:191], v[88:91]
  ds_read_b64_tr_b16 v[148:149], v13 offset:4096
  v_mfma_f32_16x16x32_bf16 v[32:35], v[180:183], v[160:163], v[32:35]
  ds_read_b64_tr_b16 v[150:151], v13 offset:4608
  v_mfma_f32_16x16x32_bf16 v[52:55], v[184:187], v[160:163], v[52:55]
  ds_read_b64_tr_b16 v[152:153], v13 offset:12288
  v_mfma_f32_16x16x32_bf16 v[72:75], v[160:163], v[188:191], v[72:75]
  ds_read_b64_tr_b16 v[154:155], v13 offset:12800
  v_mfma_f32_16x16x32_bf16 v[36:39], v[212:215], v[196:199], v[36:39]
  ds_read_b64_tr_b16 v[156:157], v13 offset:20480
  v_mfma_f32_16x16x32_bf16 v[56:59], v[216:219], v[196:199], v[56:59]
  ds_read_b64_tr_b16 v[158:159], v13 offset:20992
  v_mfma_f32_16x16x32_bf16 v[76:79], v[196:199], v[220:223], v[76:79]
  ds_read_b128 v[128:131], v12 offset:0
  v_mfma_f32_16x16x32_bf16 v[40:43], v[212:215], v[200:203], v[40:43]
  ds_read_b128 v[132:135], v12 offset:2048
  v_mfma_f32_16x16x32_bf16 v[60:63], v[216:219], v[200:203], v[60:63]
  ds_read_b128 v[136:139], v12 offset:4096
  v_mfma_f32_16x16x32_bf16 v[80:83], v[200:203], v[220:223], v[80:83]
  ds_read_b128 v[140:143], v12 offset:6144
  v_mfma_f32_16x16x32_bf16 v[44:47], v[212:215], v[204:207], v[44:47]
  ds_read_b128 v[144:147], v12 offset:8192
  v_mfma_f32_16x16x32_bf16 v[64:67], v[216:219], v[204:207], v[64:67]
  v_mfma_f32_16x16x32_bf16 v[84:87], v[204:207], v[220:223], v[84:87]
  v_mfma_f32_16x16x32_bf16 v[48:51], v[212:215], v[208:211], v[48:51]
  v_mfma_f32_16x16x32_bf16 v[68:71], v[216:219], v[208:211], v[68:71]
  v_mfma_f32_16x16x32_bf16 v[88:91], v[208:211], v[220:223], v[88:91]
  v_mfma_f32_16x16x32_bf16 v[32:35], v[212:215], v[192:195], v[32:35]
  v_mfma_f32_16x16x32_bf16 v[52:55], v[216:219], v[192:195], v[52:55]
  v_mfma_f32_16x16x32_bf16 v[72:75], v[192:195], v[220:223], v[72:75]
  s_cmp_lg_u32 s44, 1
  s_cbranch_scc1 K_pdH
  s_mov_b32 s53, 0
K_plH:
  s_waitcnt vmcnt(0)
  v_xor_b32 v24, s51, v24
  v_xor_b32 v25, s51, v25
  v_xor_b32 v26, s51, v26
  v_xor_b32 v27, s51, v27
  v_or_b32 v24, v24, v25
  v_or3_b32 v24, v24, v26, v27
  v_cmp_ne_u32 vcc, 0, v24
  s_nop 4
  s_cbranch_vccz K_pdH
  s_add_u32 s53, s53, 1
  s_cmp_lt_u32 s53, 0x80000
  s_cbranch_scc0 K_pdH
  buffer_load_dwordx4 v[24:27], v22, s[40:43], 0 offen sc1
  s_branch K_plH
K_pdH:
  s_waitcnt lgkmcnt(0)
  s_barrier
  v_min_u32 v2, 39, v1
  s_lshl_b32 s52, s49, 3
  s_sub_u32 s52, s52, 128
  v_lshlrev_b32 v2, 4, v2
  v_add_u32 v2, s52, v2
  buffer_load_dwordx4 v[228:231], v2, s[16:19], 0 offen sc1
  v_add_u32 v11, 104448, v8
  v_add_u32 v12, 104448, v9
  v_add_u32 v13, 104448, v10
  v_cndmask_b32 v96, v96, v14, s[56:57]
  v_cndmask_b32 v97, v97, v14, s[56:57]
  v_cndmask_b32 v98, v98, v14, s[56:57]
  v_cndmask_b32 v99, v99, v14, s[56:57]
  v_cndmask_b32 v128, v128, v14, s[56:57]
  v_cndmask_b32 v129, v129, v14, s[56:57]
  v_cndmask_b32 v130, v130, v14, s[56:57]
  v_cndmask_b32 v131, v131, v14, s[56:57]
  v_mfma_f32_16x16x32_bf16 v[36:39], v[116:119], v[100:103], v[36:39]
  ds_read_b64_tr_b16 v[180:181], v13 offset:0
  v_mfma_f32_16x16x32_bf16 v[56:59], v[120:123], v[100:103], v[56:59]
  ds_read_b64_tr_b16 v[182:183], v13 offset:512
  v_mfma_f32_16x16x32_bf16 v[76:79], v[100:103], v[124:127], v[76:79]
  ds_read_b64_tr_b16 v[184:185], v13 offset:8192
  v_mfma_f32_16x16x32_bf16 v[40:43], v[116:119], v[104:107], v[40:43]
  ds_read_b64_tr_b16 v[186:187], v13 offset:8704
  v_mfma_f32_16x16x32_bf16 v[60:63], v[120:123], v[104:107], v[60:63]
  ds_read_b64_tr_b16 v[188:189], v13 offset:16384
  v_mfma_f32_16x16x32_bf16 v[80:83], v[104:107], v[124:127], v[80:83]
  ds_read_b64_tr_b16 v[190:191], v13 offset:16896
  v_mfma_f32_16x16x32_bf16 v[44:47], v[116:119], v[108:111], v[44:47]
  ds_read_b128 v[160:163], v11 offset:0
  v_mfma_f32_16x16x32_bf16 v[64:67], v[120:123], v[108:111], v[64:67]
  ds_read_b128 v[164:167], v11 offset:2048
  v_mfma_f32_16x16x32_bf16 v[84:87], v[108:111], v[124:127], v[84:87]
  ds_read_b128 v[168:171], v11 offset:4096
  v_mfma_f32_16x16x32_bf16 v[48:51], v[116:119], v[112:115], v[48:51]
  ds_read_b128 v[172:175], v11 offset:6144
  v_mfma_f32_16x16x32_bf16 v[68:71], v[120:123], v[112:115], v[68:71]
  ds_read_b128 v[176:179], v11 offset:8192
  v_mfma_f32_16x16x32_bf16 v[88:91], v[112:115], v[124:127], v[88:91]
  ds_read_b64_tr_b16 v[212:213], v13 offset:4096
  v_mfma_f32_16x16x32_bf16 v[32:35], v[116:119], v[96:99], v[32:35]
  ds_read_b64_tr_b16 v[214:215], v13 offset:4608
  v_mfma_f32_16x16x32_bf16 v[52:55], v[120:123], v[96:99], v[52:55]
  ds_read_b64_tr_b16 v[216:217], v13 offset:12288
  v_mfma_f32_16x16x32_bf16 v[72:75], v[96:99], v[124:127], v[72:75]
  ds_read_b64_tr_b16 v[218:219], v13 offset:12800
  v_mfma_f32_16x16x32_bf16 v[36:39], v[148:151], v[132:135], v[36:39]
  ds_read_b64_tr_b16 v[220:221], v13 offset:20480
  v_mfma_f32_16x16x32_bf16 v[56:59], v[152:155], v[132:135], v[56:59]
  ds_read_b64_tr_b16 v[222:223], v13 offset:20992
  v_mfma_f32_16x16x32_bf16 v[76:79], v[132:135], v[156:159], v[76:79]
  ds_read_b128 v[192:195], v12 offset:0
  v_mfma_f32_16x16x32_bf16 v[40:43], v[148:151], v[136:139], v[40:43]
  ds_read_b128 v[196:199], v12 offset:2048
  v_mfma_f32_16x16x32_bf16 v[60:63], v[152:155], v[136:139], v[60:63]
  ds_read_b128 v[200:203], v12 offset:4096
  v_mfma_f32_16x16x32_bf16 v[80:83], v[136:139], v[156:159], v[80:83]
  ds_read_b128 v[204:207], v12 offset:6144
  v_mfma_f32_16x16x32_bf16 v[44:47], v[148:151], v[140:143], v[44:47]
  ds_read_b128 v[208:211], v12 offset:8192
  v_mfma_f32_16x16x32_bf16 v[64:67], v[152:155], v[140:143], v[64:67]
  v_mfma_f32_16x16x32_bf16 v[84:87], v[140:143], v[156:159], v[84:87]
  v_mfma_f32_16x16x32_bf16 v[48:51], v[148:151], v[144:147], v[48:51]
  v_mfma_f32_16x16x32_bf16 v[68:71], v[152:155], v[144:147], v[68:71]
  v_mfma_f32_16x16x32_bf16 v[88:91], v[144:147], v[156:159], v[88:91]
  v_mfma_f32_16x16x32_bf16 v[32:35], v[148:151], v[128:131], v[32:35]
  v_mfma_f32_16x16x32_bf16 v[52:55], v[152:155], v[128:131], v[52:55]
  v_mfma_f32_16x16x32_bf16 v[72:75], v[128:131], v[156:159], v[72:75]
  s_waitcnt lgkmcnt(0)
  s_barrier
  v_add_u32 v11, 16384, v28
  v_add_u32 v12, 139264, v29
  v_xor_b32 v92, 32, v11
  v_xor_b32 v93, 64, v11
  v_xor_b32 v94, 96, v11
  v_cndmask_b32 v160, v160, v14, s[56:57]
  v_cndmask_b32 v161, v161, v14, s[56:57]
  v_cndmask_b32 v162, v162, v14, s[56:57]
  v_cndmask_b32 v163, v163, v14, s[56:57]
  v_cndmask_b32 v192, v192, v14, s[56:57]
  v_cndmask_b32 v193, v193, v14, s[56:57]
  v_cndmask_b32 v194, v194, v14, s[56:57]
  v_cndmask_b32 v195, v195, v14, s[56:57]
  v_mfma_f32_16x16x32_bf16 v[36:39], v[180:183], v[164:167], v[36:39]
  ds_read_b64_tr_b16 v[112:113], v12 offset:0
  v_mfma_f32_16x16x32_bf16 v[56:59], v[184:187], v[164:167], v[56:59]
  ds_read_b64_tr_b16 v[114:115], v12 offset:2048
  v_mfma_f32_16x16x32_bf16 v[76:79], v[164:167], v[188:191], v[76:79]
  ds_read_b64_tr_b16 v[96:97], v11 offset:0
  v_mfma_f32_16x16x32_bf16 v[40:43], v[180:183], v[168:171], v[40:43]
  ds_read_b64_tr_b16 v[98:99], v11 offset:2048
  v_mfma_f32_16x16x32_bf16 v[60:63], v[184:187], v[168:171], v[60:63]
  ds_read_b64_tr_b16 v[100:101], v92 offset:0
  v_mfma_f32_16x16x32_bf16 v[80:83], v[168:171], v[188:191], v[80:83]
  ds_read_b64_tr_b16 v[102:103], v92 offset:2048
  v_mfma_f32_16x16x32_bf16 v[44:47], v[180:183], v[172:175], v[44:47]
  ds_read_b64_tr_b16 v[104:105], v93 offset:0
  v_mfma_f32_16x16x32_bf16 v[64:67], v[184:187], v[172:175], v[64:67]
  ds_read_b64_tr_b16 v[106:107], v93 offset:2048
  v_mfma_f32_16x16x32_bf16 v[84:87], v[172:175], v[188:191], v[84:87]
  ds_read_b64_tr_b16 v[108:109], v94 offset:0
  v_mfma_f32_16x16x32_bf16 v[48:51], v[180:183], v[176:179], v[48:51]
  ds_read_b64_tr_b16 v[110:111], v94 offset:2048
  v_mfma_f32_16x16x32_bf16 v[68:71], v[184:187], v[176:179], v[68:71]
  ds_read_b64_tr_b16 v[132:133], v12 offset:4096
  v_mfma_f32_16x16x32_bf16 v[88:91], v[176:179], v[188:191], v[88:91]
  ds_read_b64_tr_b16 v[134:135], v12 offset:6144
  v_mfma_f32_16x16x32_bf16 v[32:35], v[180:183], v[160:163], v[32:35]
  ds_read_b64_tr_b16 v[116:117], v11 offset:4096
  v_mfma_f32_16x16x32_bf16 v[52:55], v[184:187], v[160:163], v[52:55]
  ds_read_b64_tr_b16 v[118:119], v11 offset:6144
  v_mfma_f32_16x16x32_bf16 v[72:75], v[160:163], v[188:191], v[72:75]
  ds_read_b64_tr_b16 v[120:121], v92 offset:4096
  v_mfma_f32_16x16x32_bf16 v[36:39], v[212:215], v[196:199], v[36:39]
  ds_read_b64_tr_b16 v[122:123], v92 offset:6144
  v_mfma_f32_16x16x32_bf16 v[56:59], v[216:219], v[196:199], v[56:59]
  ds_read_b64_tr_b16 v[124:125], v93 offset:4096
  v_mfma_f32_16x16x32_bf16 v[76:79], v[196:199], v[220:223], v[76:79]
  ds_read_b64_tr_b16 v[126:127], v93 offset:6144
  v_mfma_f32_16x16x32_bf16 v[40:43], v[212:215], v[200:203], v[40:43]
  ds_read_b64_tr_b16 v[128:129], v94 offset:4096
  v_mfma_f32_16x16x32_bf16 v[60:63], v[216:219], v[200:203], v[60:63]
  ds_read_b64_tr_b16 v[130:131], v94 offset:6144
  v_mfma_f32_16x16x32_bf16 v[80:83], v[200:203], v[220:223], v[80:83]
  v_mfma_f32_16x16x32_bf16 v[44:47], v[212:215], v[204:207], v[44:47]
  v_mfma_f32_16x16x32_bf16 v[64:67], v[216:219], v[204:207], v[64:67]
  v_mfma_f32_16x16x32_bf16 v[84:87], v[204:207], v[220:223], v[84:87]
  v_mfma_f32_16x16x32_bf16 v[48:51], v[212:215], v[208:211], v[48:51]
  v_mfma_f32_16x16x32_bf16 v[68:71], v[216:219], v[208:211], v[68:71]
  v_mfma_f32_16x16x32_bf16 v[88:91], v[208:211], v[220:223], v[88:91]
  v_mfma_f32_16x16x32_bf16 v[32:35], v[212:215], v[192:195], v[32:35]
  v_mfma_f32_16x16x32_bf16 v[52:55], v[216:219], v[192:195], v[52:55]
  v_mfma_f32_16x16x32_bf16 v[72:75], v[192:195], v[220:223], v[72:75]
  s_barrier
  s_waitcnt lgkmcnt(0)
  v_add_u32 v11, 24576, v28
  v_add_u32 v12, 0, v29
  v_xor_b32 v92, 32, v11
  v_xor_b32 v93, 64, v11
  v_xor_b32 v94, 96, v11
  v_mfma_f32_16x16x32_bf16 v[232:235], v[96:99], v[112:115], v[232:235]
  ds_read_b64_tr_b16 v[152:153], v12 offset:0
  ds_read_b64_tr_b16 v[154:155], v12 offset:2048
  ds_read_b64_tr_b16 v[136:137], v11 offset:0
  v_mfma_f32_16x16x32_bf16 v[236:239], v[100:103], v[112:115], v[236:239]
  ds_read_b64_tr_b16 v[138:139], v11 offset:2048
  ds_read_b64_tr_b16 v[140:141], v92 offset:0
  ds_read_b64_tr_b16 v[142:143], v92 offset:2048
  v_mfma_f32_16x16x32_bf16 v[240:243], v[104:107], v[112:115], v[240:243]
  ds_read_b64_tr_b16 v[144:145], v93 offset:0
  ds_read_b64_tr_b16 v[146:147], v93 offset:2048
  ds_read_b64_tr_b16 v[148:149], v94 offset:0
  v_mfma_f32_16x16x32_bf16 v[244:247], v[108:111], v[112:115], v[244:247]
  ds_read_b64_tr_b16 v[150:151], v94 offset:2048
  ds_read_b64_tr_b16 v[172:173], v12 offset:4096
  ds_read_b64_tr_b16 v[174:175], v12 offset:6144
  v_mfma_f32_16x16x32_bf16 v[232:235], v[116:119], v[132:135], v[232:235]
  ds_read_b64_tr_b16 v[156:157], v11 offset:4096
  ds_read_b64_tr_b16 v[158:159], v11 offset:6144
  ds_read_b64_tr_b16 v[160:161], v92 offset:4096
  v_mfma_f32_16x16x32_bf16 v[236:239], v[120:123], v[132:135], v[236:239]
  ds_read_b64_tr_b16 v[162:163], v92 offset:6144
  ds_read_b64_tr_b16 v[164:165], v93 offset:4096
  ds_read_b64_tr_b16 v[166:167], v93 offset:6144
  v_mfma_f32_16x16x32_bf16 v[240:243], v[124:127], v[132:135], v[240:243]
  ds_read_b64_tr_b16 v[168:169], v94 offset:4096
  ds_read_b64_tr_b16 v[170:171], v94 offset:6144
  v_mfma_f32_16x16x32_bf16 v[244:247], v[128:131], v[132:135], v[244:247]
  s_mul_i32 s91, s44, 2304
  s_add_u32 s91, s91, 154624
  v_min_u32 v226, 39, v1
  v_lshlrev_b32 v226, 4, v226
  v_add_u32 v226, s91, v226
  s_waitcnt vmcnt(0)
  ds_write_b128 v226, v[228:231]
  v_lshrrev_b32 v227, 4, v1
  v_lshlrev_b32 v227, 5, v227
  v_add_u32 v227, s91, v227
  v_and_b32 v226, 15, v1
  v_lshlrev_b32 v226, 3, v226
  v_add_u32 v226, s91, v226
  s_waitcnt lgkmcnt(0)
  ds_read_b128 v[176:179], v227 offset:0
  ds_read_b128 v[180:183], v227 offset:16
  ds_read_b128 v[184:187], v227 offset:128
  ds_read_b128 v[188:191], v227 offset:144
  ds_read_b128 v[192:195], v227 offset:256
  ds_read_b128 v[196:199], v227 offset:272
  ds_read_b128 v[200:203], v227 offset:384
  ds_read_b128 v[204:207], v227 offset:400
  ds_read_b128 v[208:211], v227 offset:512
  ds_read_b128 v[212:215], v227 offset:528
  v_mov_b32 v95, v72
  v_mov_b32 v228, v95
  s_nop 1
  v_permlane16_swap_b32 v95, v228
  v_mov_b32 v228, v95
  s_nop 1
  v_permlane32_swap_b32 v95, v228
  s_barrier
  s_waitcnt lgkmcnt(0)
  v_add_u32 v11, 32768, v28
  v_add_u32 v12, 8192, v29
  v_xor_b32 v92, 32, v11
  v_xor_b32 v93, 64, v11
  v_xor_b32 v94, 96, v11
  v_mfma_f32_16x16x32_bf16 v[232:235], v[136:139], v[152:155], v[232:235]
  ds_read_b64_tr_b16 v[112:113], v12 offset:0
  ds_read_b64_tr_b16 v[114:115], v12 offset:2048
  ds_read_b64_tr_b16 v[96:97], v11 offset:0
  v_mfma_f32_16x16x32_bf16 v[236:239], v[140:143], v[152:155], v[236:239]
  ds_read_b64_tr_b16 v[98:99], v11 offset:2048
  ds_read_b64_tr_b16 v[100:101], v92 offset:0
  ds_read_b64_tr_b16 v[102:103], v92 offset:2048
  v_mfma_f32_16x16x32_bf16 v[240:243], v[144:147], v[152:155], v[240:243]
  ds_read_b64_tr_b16 v[104:105], v93 offset:0
  ds_read_b64_tr_b16 v[106:107], v93 offset:2048
  ds_read_b64_tr_b16 v[108:109], v94 offset:0
  v_mfma_f32_16x16x32_bf16 v[244:247], v[148:151], v[152:155], v[244:247]
  ds_read_b64_tr_b16 v[110:111], v94 offset:2048
  ds_read_b64_tr_b16 v[132:133], v12 offset:4096
  ds_read_b64_tr_b16 v[134:135], v12 offset:6144
  v_mfma_f32_16x16x32_bf16 v[232:235], v[156:159], v[172:175], v[232:235]
  ds_read_b64_tr_b16 v[116:117], v11 offset:4096
  ds_read_b64_tr_b16 v[118:119], v11 offset:6144
  ds_read_b64_tr_b16 v[120:121], v92 offset:4096
  v_mfma_f32_16x16x32_bf16 v[236:239], v[160:163], v[172:175], v[236:239]
  ds_read_b64_tr_b16 v[122:123], v92 offset:6144
  ds_read_b64_tr_b16 v[124:125], v93 offset:4096
  ds_read_b64_tr_b16 v[126:127], v93 offset:6144
  v_mfma_f32_16x16x32_bf16 v[240:243], v[164:167], v[172:175], v[240:243]
  ds_read_b64_tr_b16 v[128:129], v94 offset:4096
  ds_read_b64_tr_b16 v[130:131], v94 offset:6144
  v_mfma_f32_16x16x32_bf16 v[244:247], v[168:171], v[172:175], v[244:247]
  s_waitcnt lgkmcnt(0)
  v_mul_f32 v228, v177, v95
  v_mul_f32 v229, v179, v95
  v_mul_f32 v230, v181, v95
  v_mul_f32 v231, v183, v95
  v_fma_f32 v72, v176, v72, v228
  v_fma_f32 v73, v178, v73, v229
  v_fma_f32 v74, v180, v74, v230
  v_fma_f32 v75, v182, v75, v231
  v_cvt_pk_bf16_f32 v216, v72, v73
  v_cvt_pk_bf16_f32 v217, v74, v75
  v_mul_f32 v228, v185, v95
  v_mul_f32 v229, v187, v95
  v_mul_f32 v230, v189, v95
  v_mul_f32 v231, v191, v95
  v_fma_f32 v76, v184, v76, v228
  v_fma_f32 v77, v186, v77, v229
  v_fma_f32 v78, v188, v78, v230
  v_fma_f32 v79, v190, v79, v231
  v_cvt_pk_bf16_f32 v218, v76, v77
  v_cvt_pk_bf16_f32 v219, v78, v79
  v_mul_f32 v228, v193, v95
  v_mul_f32 v229, v195, v95
  v_mul_f32 v230, v197, v95
  v_mul_f32 v231, v199, v95
  v_fma_f32 v80, v192, v80, v228
  v_fma_f32 v81, v194, v81, v229
  v_fma_f32 v82, v196, v82, v230
  v_fma_f32 v83, v198, v83, v231
  v_cvt_pk_bf16_f32 v220, v80, v81
  v_cvt_pk_bf16_f32 v221, v82, v83
  s_barrier
  s_waitcnt lgkmcnt(0)
  v_add_u32 v11, 40960, v28
  v_add_u32 v12, 49152, v29
  v_xor_b32 v92, 32, v11
  v_xor_b32 v93, 64, v11
  v_xor_b32 v94, 96, v11
  v_mfma_f32_16x16x32_bf16 v[232:235], v[96:99], v[112:115], v[232:235]
  ds_read_b64_tr_b16 v[152:153], v12 offset:0
  ds_read_b64_tr_b16 v[154:155], v12 offset:2048
  ds_read_b64_tr_b16 v[136:137], v11 offset:0
  v_mfma_f32_16x16x32_bf16 v[236:239], v[100:103], v[112:115], v[236:239]
  ds_read_b64_tr_b16 v[138:139], v11 offset:2048
  ds_read_b64_tr_b16 v[140:141], v92 offset:0
  ds_read_b64_tr_b16 v[142:143], v92 offset:2048
  v_mfma_f32_16x16x32_bf16 v[240:243], v[104:107], v[112:115], v[240:243]
  ds_read_b64_tr_b16 v[144:145], v93 offset:0
  ds_read_b64_tr_b16 v[146:147], v93 offset:2048
  ds_read_b64_tr_b16 v[148:149], v94 offset:0
  v_mfma_f32_16x16x32_bf16 v[244:247], v[108:111], v[112:115], v[244:247]
  ds_read_b64_tr_b16 v[150:151], v94 offset:2048
  ds_read_b64_tr_b16 v[172:173], v12 offset:4096
  ds_read_b64_tr_b16 v[174:175], v12 offset:6144
  v_mfma_f32_16x16x32_bf16 v[232:235], v[116:119], v[132:135], v[232:235]
  ds_read_b64_tr_b16 v[156:157], v11 offset:4096
  ds_read_b64_tr_b16 v[158:159], v11 offset:6144
  ds_read_b64_tr_b16 v[160:161], v92 offset:4096
  v_mfma_f32_16x16x32_bf16 v[236:239], v[120:123], v[132:135], v[236:239]
  ds_read_b64_tr_b16 v[162:163], v92 offset:6144
  ds_read_b64_tr_b16 v[164:165], v93 offset:4096
  ds_read_b64_tr_b16 v[166:167], v93 offset:6144
  v_mfma_f32_16x16x32_bf16 v[240:243], v[124:127], v[132:135], v[240:243]
  ds_read_b64_tr_b16 v[168:169], v94 offset:4096
  ds_read_b64_tr_b16 v[170:171], v94 offset:6144
  v_mfma_f32_16x16x32_bf16 v[244:247], v[128:131], v[132:135], v[244:247]
  v_mul_f32 v228, v201, v95
  v_mul_f32 v229, v203, v95
  v_mul_f32 v230, v205, v95
  v_mul_f32 v231, v207, v95
  v_fma_f32 v84, v200, v84, v228
  v_fma_f32 v85, v202, v85, v229
  v_fma_f32 v86, v204, v86, v230
  v_fma_f32 v87, v206, v87, v231
  v_cvt_pk_bf16_f32 v222, v84, v85
  v_cvt_pk_bf16_f32 v223, v86, v87
  v_mul_f32 v228, v209, v95
  v_mul_f32 v229, v211, v95
  v_mul_f32 v230, v213, v95
  v_mul_f32 v231, v215, v95
  v_fma_f32 v88, v208, v88, v228
  v_fma_f32 v89, v210, v89, v229
  v_fma_f32 v90, v212, v90, v230
  v_fma_f32 v91, v214, v91, v231
  v_cvt_pk_bf16_f32 v224, v88, v89
  v_cvt_pk_bf16_f32 v225, v90, v91
  ds_read_b64 v[176:177], v226 offset:0
  ds_read_b64 v[178:179], v226 offset:128
  ds_read_b64 v[180:181], v226 offset:256
  ds_read_b64 v[182:183], v226 offset:384
  ds_read_b64 v[184:185], v226 offset:512
  v_mov_b32_dpp v186, v32 row_newbcast:0 row_mask:0xf bank_mask:0xf
  v_mov_b32_dpp v190, v52 row_newbcast:0 row_mask:0xf bank_mask:0xf
  v_mov_b32_dpp v187, v33 row_newbcast:0 row_mask:0xf bank_mask:0xf
  v_mov_b32_dpp v191, v53 row_newbcast:0 row_mask:0xf bank_mask:0xf
  v_mov_b32_dpp v188, v34 row_newbcast:0 row_mask:0xf bank_mask:0xf
  v_mov_b32_dpp v192, v54 row_newbcast:0 row_mask:0xf bank_mask:0xf
  v_mov_b32_dpp v189, v35 row_newbcast:0 row_mask:0xf bank_mask:0xf
  v_mov_b32_dpp v193, v55 row_newbcast:0 row_mask:0xf bank_mask:0xf
  s_waitcnt lgkmcnt(0)
  s_barrier
  s_waitcnt lgkmcnt(0)
  v_add_u32 v11, 57344, v28
  v_add_u32 v12, 65536, v29
  v_xor_b32 v92, 32, v11
  v_xor_b32 v93, 64, v11
  v_xor_b32 v94, 96, v11
  v_mfma_f32_16x16x32_bf16 v[232:235], v[136:139], v[152:155], v[232:235]
  ds_read_b64_tr_b16 v[112:113], v12 offset:0
  ds_read_b64_tr_b16 v[114:115], v12 offset:2048
  ds_read_b64_tr_b16 v[96:97], v11 offset:0
  v_mfma_f32_16x16x32_bf16 v[236:239], v[140:143], v[152:155], v[236:239]
  ds_read_b64_tr_b16 v[98:99], v11 offset:2048
  ds_read_b64_tr_b16 v[100:101], v92 offset:0
  ds_read_b64_tr_b16 v[102:103], v92 offset:2048
  v_mfma_f32_16x16x32_bf16 v[240:243], v[144:147], v[152:155], v[240:243]
  ds_read_b64_tr_b16 v[104:105], v93 offset:0
  ds_read_b64_tr_b16 v[106:107], v93 offset:2048
  ds_read_b64_tr_b16 v[108:109], v94 offset:0
  v_mfma_f32_16x16x32_bf16 v[244:247], v[148:151], v[152:155], v[244:247]
  ds_read_b64_tr_b16 v[110:111], v94 offset:2048
  ds_read_b64_tr_b16 v[132:133], v12 offset:4096
  ds_read_b64_tr_b16 v[134:135], v12 offset:6144
  v_mfma_f32_16x16x32_bf16 v[232:235], v[156:159], v[172:175], v[232:235]
  ds_read_b64_tr_b16 v[116:117], v11 offset:4096
  ds_read_b64_tr_b16 v[118:119], v11 offset:6144
  ds_read_b64_tr_b16 v[120:121], v92 offset:4096
  v_mfma_f32_16x16x32_bf16 v[236:239], v[160:163], v[172:175], v[236:239]
  ds_read_b64_tr_b16 v[122:123], v92 offset:6144
  ds_read_b64_tr_b16 v[124:125], v93 offset:4096
  ds_read_b64_tr_b16 v[126:127], v93 offset:6144
  v_mfma_f32_16x16x32_bf16 v[240:243], v[164:167], v[172:175], v[240:243]
  ds_read_b64_tr_b16 v[128:129], v94 offset:4096
  ds_read_b64_tr_b16 v[130:131], v94 offset:6144
  v_mfma_f32_16x16x32_bf16 v[244:247], v[168:171], v[172:175], v[244:247]
  v_mul_f32 v228, v179, v186
  v_mul_f32 v229, v179, v187
  v_mul_f32 v230, v179, v188
  v_mul_f32 v231, v179, v189
  v_fma_f32 v36, v178, v36, v228
  v_fma_f32 v37, v178, v37, v229
  v_fma_f32 v38, v178, v38, v230
  v_fma_f32 v39, v178, v39, v231
  v_cvt_pk_bf16_f32 v194, v36, v37
  v_cvt_pk_bf16_f32 v195, v38, v39
  v_mul_f32 v228, v181, v186
  v_mul_f32 v229, v181, v187
  v_mul_f32 v230, v181, v188
  v_mul_f32 v231, v181, v189
  v_fma_f32 v40, v180, v40, v228
  v_fma_f32 v41, v180, v41, v229
  v_fma_f32 v42, v180, v42, v230
  v_fma_f32 v43, v180, v43, v231
  v_cvt_pk_bf16_f32 v196, v40, v41
  v_cvt_pk_bf16_f32 v197, v42, v43
  v_mul_f32 v228, v183, v186
  v_mul_f32 v229, v183, v187
  v_mul_f32 v230, v183, v188
  v_mul_f32 v231, v183, v189
  v_fma_f32 v44, v182, v44, v228
  v_fma_f32 v45, v182, v45, v229
  v_fma_f32 v46, v182, v46, v230
  v_fma_f32 v47, v182, v47, v231
  v_cvt_pk_bf16_f32 v198, v44, v45
  v_cvt_pk_bf16_f32 v199, v46, v47
  s_barrier
  s_waitcnt lgkmcnt(0)
  v_add_u32 v11, 73728, v28
  v_add_u32 v12, 81920, v29
  v_xor_b32 v92, 32, v11
  v_xor_b32 v93, 64, v11
  v_xor_b32 v94, 96, v11
  v_mfma_f32_16x16x32_bf16 v[232:235], v[96:99], v[112:115], v[232:235]
  ds_read_b64_tr_b16 v[152:153], v12 offset:0
  ds_read_b64_tr_b16 v[154:155], v12 offset:2048
  ds_read_b64_tr_b16 v[136:137], v11 offset:0
  v_mfma_f32_16x16x32_bf16 v[236:239], v[100:103], v[112:115], v[236:239]
  ds_read_b64_tr_b16 v[138:139], v11 offset:2048
  ds_read_b64_tr_b16 v[140:141], v92 offset:0
  ds_read_b64_tr_b16 v[142:143], v92 offset:2048
  v_mfma_f32_16x16x32_bf16 v[240:243], v[104:107], v[112:115], v[240:243]
  ds_read_b64_tr_b16 v[144:145], v93 offset:0
  ds_read_b64_tr_b16 v[146:147], v93 offset:2048
  ds_read_b64_tr_b16 v[148:149], v94 offset:0
  v_mfma_f32_16x16x32_bf16 v[244:247], v[108:111], v[112:115], v[244:247]
  ds_read_b64_tr_b16 v[150:151], v94 offset:2048
  ds_read_b64_tr_b16 v[172:173], v12 offset:4096
  ds_read_b64_tr_b16 v[174:175], v12 offset:6144
  v_mfma_f32_16x16x32_bf16 v[232:235], v[116:119], v[132:135], v[232:235]
  ds_read_b64_tr_b16 v[156:157], v11 offset:4096
  ds_read_b64_tr_b16 v[158:159], v11 offset:6144
  ds_read_b64_tr_b16 v[160:161], v92 offset:4096
  v_mfma_f32_16x16x32_bf16 v[236:239], v[120:123], v[132:135], v[236:239]
  ds_read_b64_tr_b16 v[162:163], v92 offset:6144
  ds_read_b64_tr_b16 v[164:165], v93 offset:4096
  ds_read_b64_tr_b16 v[166:167], v93 offset:6144
  v_mfma_f32_16x16x32_bf16 v[240:243], v[124:127], v[132:135], v[240:243]
  ds_read_b64_tr_b16 v[168:169], v94 offset:4096
  ds_read_b64_tr_b16 v[170:171], v94 offset:6144
  v_mfma_f32_16x16x32_bf16 v[244:247], v[128:131], v[132:135], v[244:247]
  v_mul_f32 v228, v185, v186
  v_mul_f32 v229, v185, v187
  v_mul_f32 v230, v185, v188
  v_mul_f32 v231, v185, v189
  v_fma_f32 v48, v184, v48, v228
  v_fma_f32 v49, v184, v49, v229
  v_fma_f32 v50, v184, v50, v230
  v_fma_f32 v51, v184, v51, v231
  v_cvt_pk_bf16_f32 v200, v48, v49
  v_cvt_pk_bf16_f32 v201, v50, v51
  v_mul_f32 v228, v177, v190
  v_mul_f32 v229, v177, v191
  v_mul_f32 v230, v177, v192
  v_mul_f32 v231, v177, v193
  v_fma_f32 v52, v176, v52, v228
  v_fma_f32 v53, v176, v53, v229
  v_fma_f32 v54, v176, v54, v230
  v_fma_f32 v55, v176, v55, v231
  v_cvt_pk_bf16_f32 v202, v52, v53
  v_cvt_pk_bf16_f32 v203, v54, v55
  v_mul_f32 v228, v179, v190
  v_mul_f32 v229, v179, v191
  v_mul_f32 v230, v179, v192
  v_mul_f32 v231, v179, v193
  v_fma_f32 v56, v178, v56, v228
  v_fma_f32 v57, v178, v57, v229
  v_fma_f32 v58, v178, v58, v230
  v_fma_f32 v59, v178, v59, v231
  v_cvt_pk_bf16_f32 v204, v56, v57
  v_cvt_pk_bf16_f32 v205, v58, v59
  s_barrier
  s_waitcnt lgkmcnt(0)
  v_add_u32 v11, 16384, v28
  v_add_u32 v12, 90112, v29
  v_xor_b32 v92, 32, v11
  v_xor_b32 v93, 64, v11
  v_xor_b32 v94, 96, v11
  v_mfma_f32_16x16x32_bf16 v[232:235], v[136:139], v[152:155], v[232:235]
  ds_read_b64_tr_b16 v[112:113], v12 offset:0
  ds_read_b64_tr_b16 v[114:115], v12 offset:2048
  ds_read_b64_tr_b16 v[96:97], v11 offset:0
  v_mfma_f32_16x16x32_bf16 v[236:239], v[140:143], v[152:155], v[236:239]
  ds_read_b64_tr_b16 v[98:99], v11 offset:2048
  ds_read_b64_tr_b16 v[100:101], v92 offset:0
  ds_read_b64_tr_b16 v[102:103], v92 offset:2048
  v_mfma_f32_16x16x32_bf16 v[240:243], v[144:147], v[152:155], v[240:243]
  ds_read_b64_tr_b16 v[104:105], v93 offset:0
  ds_read_b64_tr_b16 v[106:107], v93 offset:2048
  ds_read_b64_tr_b16 v[108:109], v94 offset:0
  v_mfma_f32_16x16x32_bf16 v[244:247], v[148:151], v[152:155], v[244:247]
  ds_read_b64_tr_b16 v[110:111], v94 offset:2048
  ds_read_b64_tr_b16 v[132:133], v12 offset:4096
  ds_read_b64_tr_b16 v[134:135], v12 offset:6144
  v_mfma_f32_16x16x32_bf16 v[232:235], v[156:159], v[172:175], v[232:235]
  ds_read_b64_tr_b16 v[116:117], v11 offset:4096
  ds_read_b64_tr_b16 v[118:119], v11 offset:6144
  ds_read_b64_tr_b16 v[120:121], v92 offset:4096
  v_mfma_f32_16x16x32_bf16 v[236:239], v[160:163], v[172:175], v[236:239]
  ds_read_b64_tr_b16 v[122:123], v92 offset:6144
  ds_read_b64_tr_b16 v[124:125], v93 offset:4096
  ds_read_b64_tr_b16 v[126:127], v93 offset:6144
  v_mfma_f32_16x16x32_bf16 v[240:243], v[164:167], v[172:175], v[240:243]
  ds_read_b64_tr_b16 v[128:129], v94 offset:4096
  ds_read_b64_tr_b16 v[130:131], v94 offset:6144
  v_mfma_f32_16x16x32_bf16 v[244:247], v[168:171], v[172:175], v[244:247]
  v_mul_f32 v228, v181, v190
  v_mul_f32 v229, v181, v191
  v_mul_f32 v230, v181, v192
  v_mul_f32 v231, v181, v193
  v_fma_f32 v60, v180, v60, v228
  v_fma_f32 v61, v180, v61, v229
  v_fma_f32 v62, v180, v62, v230
  v_fma_f32 v63, v180, v63, v231
  v_cvt_pk_bf16_f32 v206, v60, v61
  v_cvt_pk_bf16_f32 v207, v62, v63
  v_mul_f32 v228, v183, v190
  v_mul_f32 v229, v183, v191
  v_mul_f32 v230, v183, v192
  v_mul_f32 v231, v183, v193
  v_fma_f32 v64, v182, v64, v228
  v_fma_f32 v65, v182, v65, v229
  v_fma_f32 v66, v182, v66, v230
  v_fma_f32 v67, v182, v67, v231
  v_cvt_pk_bf16_f32 v208, v64, v65
  v_cvt_pk_bf16_f32 v209, v66, v67
  v_mul_f32 v228, v185, v190
  v_mul_f32 v229, v185, v191
  v_mul_f32 v230, v185, v192
  v_mul_f32 v231, v185, v193
  v_fma_f32 v68, v184, v68, v228
  v_fma_f32 v69, v184, v69, v229
  v_fma_f32 v70, v184, v70, v230
  v_fma_f32 v71, v184, v71, v231
  v_cvt_pk_bf16_f32 v210, v68, v69
  v_cvt_pk_bf16_f32 v211, v70, v71
  s_barrier
  s_waitcnt lgkmcnt(0)
  v_add_u32 v11, 98304, v28
  v_add_u32 v12, 0, v29
  v_xor_b32 v92, 32, v11
  v_xor_b32 v93, 64, v11
  v_xor_b32 v94, 96, v11
  v_mfma_f32_16x16x32_bf16 v[232:235], v[96:99], v[112:115], v[232:235]
  ds_read_b64_tr_b16 v[152:153], v12 offset:0
  ds_read_b64_tr_b16 v[154:155], v12 offset:2048
  ds_read_b64_tr_b16 v[136:137], v11 offset:0
  v_mfma_f32_16x16x32_bf16 v[236:239], v[100:103], v[112:115], v[236:239]
  ds_read_b64_tr_b16 v[138:139], v11 offset:2048
  ds_read_b64_tr_b16 v[140:141], v92 offset:0
  ds_read_b64_tr_b16 v[142:143], v92 offset:2048
  v_mfma_f32_16x16x32_bf16 v[240:243], v[104:107], v[112:115], v[240:243]
  ds_read_b64_tr_b16 v[144:145], v93 offset:0
  ds_read_b64_tr_b16 v[146:147], v93 offset:2048
  ds_read_b64_tr_b16 v[148:149], v94 offset:0
  v_mfma_f32_16x16x32_bf16 v[244:247], v[108:111], v[112:115], v[244:247]
  ds_read_b64_tr_b16 v[150:151], v94 offset:2048
  ds_read_b64_tr_b16 v[172:173], v12 offset:4096
  ds_read_b64_tr_b16 v[174:175], v12 offset:6144
  v_mfma_f32_16x16x32_bf16 v[232:235], v[116:119], v[132:135], v[232:235]
  ds_read_b64_tr_b16 v[156:157], v11 offset:4096
  ds_read_b64_tr_b16 v[158:159], v11 offset:6144
  ds_read_b64_tr_b16 v[160:161], v92 offset:4096
  v_mfma_f32_16x16x32_bf16 v[236:239], v[120:123], v[132:135], v[236:239]
  ds_read_b64_tr_b16 v[162:163], v92 offset:6144
  ds_read_b64_tr_b16 v[164:165], v93 offset:4096
  ds_read_b64_tr_b16 v[166:167], v93 offset:6144
  v_mfma_f32_16x16x32_bf16 v[240:243], v[124:127], v[132:135], v[240:243]
  ds_read_b64_tr_b16 v[168:169], v94 offset:4096
  ds_read_b64_tr_b16 v[170:171], v94 offset:6144
  v_mfma_f32_16x16x32_bf16 v[244:247], v[128:131], v[132:135], v[244:247]
  v_mfma_f32_16x16x16_bf16 v[36:39], v[202:203], v[194:195], 0
  v_mfma_f32_16x16x16_bf16 v[56:59], v[204:205], v[194:195], 0
  v_mfma_f32_16x16x16_bf16 v[40:43], v[204:205], v[196:197], 0
  v_mfma_f32_16x16x16_bf16 v[60:63], v[206:207], v[196:197], 0
  v_mfma_f32_16x16x16_bf16 v[44:47], v[206:207], v[198:199], 0
  v_mfma_f32_16x16x16_bf16 v[64:67], v[208:209], v[198:199], 0
  v_mfma_f32_16x16x16_bf16 v[48:51], v[208:209], v[200:201], 0
  v_mfma_f32_16x16x16_bf16 v[68:71], v[210:211], v[200:201], 0
  s_nop 0
  v_cndmask_b32 v176, v36, v37, s[58:59]
  v_cndmask_b32 v180, v38, v39, s[58:59]
  v_cndmask_b32 v184, v56, v57, s[58:59]
  v_cndmask_b32 v188, v58, v59, s[58:59]
  v_cndmask_b32 v177, v40, v41, s[58:59]
  v_cndmask_b32 v181, v42, v43, s[58:59]
  v_cndmask_b32 v185, v60, v61, s[58:59]
  v_cndmask_b32 v189, v62, v63, s[58:59]
  v_cndmask_b32 v178, v44, v45, s[58:59]
  v_cndmask_b32 v182, v46, v47, s[58:59]
  v_cndmask_b32 v186, v64, v65, s[58:59]
  v_cndmask_b32 v190, v66, v67, s[58:59]
  v_cndmask_b32 v179, v48, v49, s[58:59]
  v_cndmask_b32 v183, v50, v51, s[58:59]
  v_cndmask_b32 v187, v68, v69, s[58:59]
  v_cndmask_b32 v191, v70, v71, s[58:59]
  v_add_f32 v176, s90, v176
  v_add_f32 v180, s90, v180
  s_barrier
  s_waitcnt lgkmcnt(0)
  v_add_u32 v11, 24576, v28
  v_add_u32 v12, 106496, v29
  v_xor_b32 v92, 32, v11
  v_xor_b32 v93, 64, v11
  v_xor_b32 v94, 96, v11
  v_mfma_f32_16x16x32_bf16 v[232:235], v[136:139], v[152:155], v[232:235]
  ds_read_b64_tr_b16 v[112:113], v12 offset:0
  ds_read_b64_tr_b16 v[114:115], v12 offset:2048
  ds_read_b64_tr_b16 v[96:97], v11 offset:0
  v_mfma_f32_16x16x32_bf16 v[236:239], v[140:143], v[152:155], v[236:239]
  ds_read_b64_tr_b16 v[98:99], v11 offset:2048
  ds_read_b64_tr_b16 v[100:101], v92 offset:0
  ds_read_b64_tr_b16 v[102:103], v92 offset:2048
  v_mfma_f32_16x16x32_bf16 v[240:243], v[144:147], v[152:155], v[240:243]
  ds_read_b64_tr_b16 v[104:105], v93 offset:0
  ds_read_b64_tr_b16 v[106:107], v93 offset:2048
  ds_read_b64_tr_b16 v[108:109], v94 offset:0
  v_mfma_f32_16x16x32_bf16 v[244:247], v[148:151], v[152:155], v[244:247]
  ds_read_b64_tr_b16 v[110:111], v94 offset:2048
  ds_read_b64_tr_b16 v[132:133], v12 offset:4096
  ds_read_b64_tr_b16 v[134:135], v12 offset:6144
  v_mfma_f32_16x16x32_bf16 v[232:235], v[156:159], v[172:175], v[232:235]
  ds_read_b64_tr_b16 v[116:117], v11 offset:4096
  ds_read_b64_tr_b16 v[118:119], v11 offset:6144
  ds_read_b64_tr_b16 v[120:121], v92 offset:4096
  v_mfma_f32_16x16x32_bf16 v[236:239], v[160:163], v[172:175], v[236:239]
  ds_read_b64_tr_b16 v[122:123], v92 offset:6144
  ds_read_b64_tr_b16 v[124:125], v93 offset:4096
  ds_read_b64_tr_b16 v[126:127], v93 offset:6144
  v_mfma_f32_16x16x32_bf16 v[240:243], v[164:167], v[172:175], v[240:243]
  ds_read_b64_tr_b16 v[128:129], v94 offset:4096
  ds_read_b64_tr_b16 v[130:131], v94 offset:6144
  v_mfma_f32_16x16x32_bf16 v[244:247], v[168:171], v[172:175], v[244:247]
  v_cndmask_b32 v176, v184, v176, s[86:87]
  v_cndmask_b32 v180, v188, v180, s[88:89]
  v_cndmask_b32 v177, v185, v177, s[86:87]
  v_cndmask_b32 v181, v189, v181, s[88:89]
  v_cndmask_b32 v178, v186, v178, s[86:87]
  v_cndmask_b32 v182, v190, v182, s[88:89]
  v_cndmask_b32 v179, v187, v179, s[86:87]
  v_cndmask_b32 v183, v191, v183, s[88:89]
  v_max_f32 v188, v176, v180
  v_max_f32 v189, v177, v181
  v_max_f32 v190, v178, v182
  v_max_f32 v191, v179, v183
  v_mov_b32 v192, v188
  v_mov_b32 v193, v189
  v_mov_b32 v194, v190
  v_mov_b32 v195, v191
  v_permlane16_swap_b32 v188, v192
  v_permlane16_swap_b32 v189, v193
  v_permlane16_swap_b32 v190, v194
  v_permlane16_swap_b32 v191, v195
  v_max_f32 v188, v188, v192
  v_max_f32 v189, v189, v193
  v_max_f32 v190, v190, v194
  v_max_f32 v191, v191, v195
  v_mov_b32 v192, v188
  v_mov_b32 v193, v189
  v_mov_b32 v194, v190
  v_mov_b32 v195, v191
  v_permlane32_swap_b32 v188, v192
  v_permlane32_swap_b32 v189, v193
  v_permlane32_swap_b32 v190, v194
  v_permlane32_swap_b32 v191, v195
  v_max_f32 v188, v188, v192
  v_max_f32 v189, v189, v193
  v_max_f32 v190, v190, v194
  v_max_f32 v191, v191, v195
  s_barrier
  s_waitcnt lgkmcnt(0)
  v_add_u32 v11, 8192, v28
  v_add_u32 v12, 32768, v29
  v_xor_b32 v92, 32, v11
  v_xor_b32 v93, 64, v11
  v_xor_b32 v94, 96, v11
  v_mfma_f32_16x16x32_bf16 v[232:235], v[96:99], v[112:115], v[232:235]
  ds_read_b64_tr_b16 v[152:153], v12 offset:0
  ds_read_b64_tr_b16 v[154:155], v12 offset:2048
  ds_read_b64_tr_b16 v[136:137], v11 offset:0
  v_mfma_f32_16x16x32_bf16 v[236:239], v[100:103], v[112:115], v[236:239]
  ds_read_b64_tr_b16 v[138:139], v11 offset:2048
  ds_read_b64_tr_b16 v[140:141], v92 offset:0
  ds_read_b64_tr_b16 v[142:143], v92 offset:2048
  v_mfma_f32_16x16x32_bf16 v[240:243], v[104:107], v[112:115], v[240:243]
  ds_read_b64_tr_b16 v[144:145], v93 offset:0
  ds_read_b64_tr_b16 v[146:147], v93 offset:2048
  ds_read_b64_tr_b16 v[148:149], v94 offset:0
  v_mfma_f32_16x16x32_bf16 v[244:247], v[108:111], v[112:115], v[244:247]
  ds_read_b64_tr_b16 v[150:151], v94 offset:2048
  ds_read_b64_tr_b16 v[172:173], v12 offset:4096
  ds_read_b64_tr_b16 v[174:175], v12 offset:6144
  v_mfma_f32_16x16x32_bf16 v[232:235], v[116:119], v[132:135], v[232:235]
  ds_read_b64_tr_b16 v[156:157], v11 offset:4096
  ds_read_b64_tr_b16 v[158:159], v11 offset:6144
  ds_read_b64_tr_b16 v[160:161], v92 offset:4096
  v_mfma_f32_16x16x32_bf16 v[236:239], v[120:123], v[132:135], v[236:239]
  ds_read_b64_tr_b16 v[162:163], v92 offset:6144
  ds_read_b64_tr_b16 v[164:165], v93 offset:4096
  ds_read_b64_tr_b16 v[166:167], v93 offset:6144
  v_mfma_f32_16x16x32_bf16 v[240:243], v[124:127], v[132:135], v[240:243]
  ds_read_b64_tr_b16 v[168:169], v94 offset:4096
  ds_read_b64_tr_b16 v[170:171], v94 offset:6144
  v_mfma_f32_16x16x32_bf16 v[244:247], v[128:131], v[132:135], v[244:247]
  s_mov_b32 s91, 0x3eb8aa3b
  v_mul_f32 v188, s91, v188
  v_mul_f32 v189, s91, v189
  v_mul_f32 v190, s91, v190
  v_mul_f32 v191, s91, v191
  v_fma_f32 v176, v176, s91, -v188
  v_fma_f32 v180, v180, s91, -v188
  v_fma_f32 v177, v177, s91, -v189
  v_fma_f32 v181, v181, s91, -v189
  v_fma_f32 v178, v178, s91, -v190
  v_fma_f32 v182, v182, s91, -v190
  v_fma_f32 v179, v179, s91, -v191
  v_fma_f32 v183, v183, s91, -v191
  v_exp_f32 v176, v176
  v_exp_f32 v180, v180
  v_exp_f32 v177, v177
  v_exp_f32 v181, v181
  v_exp_f32 v178, v178
  v_exp_f32 v182, v182
  v_exp_f32 v179, v179
  v_exp_f32 v183, v183
  v_add_f32 v184, v176, v180
  v_add_f32 v185, v177, v181
  v_add_f32 v186, v178, v182
  v_add_f32 v187, v179, v183
  s_barrier
  s_waitcnt lgkmcnt(0)
  v_add_u32 v11, 114688, v28
  v_add_u32 v12, 40960, v29
  v_xor_b32 v92, 32, v11
  v_xor_b32 v93, 64, v11
  v_xor_b32 v94, 96, v11
  v_mfma_f32_16x16x32_bf16 v[232:235], v[136:139], v[152:155], v[232:235]
  ds_read_b64_tr_b16 v[112:113], v12 offset:0
  ds_read_b64_tr_b16 v[114:115], v12 offset:2048
  ds_read_b64_tr_b16 v[96:97], v11 offset:0
  v_mfma_f32_16x16x32_bf16 v[236:239], v[140:143], v[152:155], v[236:239]
  ds_read_b64_tr_b16 v[98:99], v11 offset:2048
  ds_read_b64_tr_b16 v[100:101], v92 offset:0
  ds_read_b64_tr_b16 v[102:103], v92 offset:2048
  v_mfma_f32_16x16x32_bf16 v[240:243], v[144:147], v[152:155], v[240:243]
  ds_read_b64_tr_b16 v[104:105], v93 offset:0
  ds_read_b64_tr_b16 v[106:107], v93 offset:2048
  ds_read_b64_tr_b16 v[108:109], v94 offset:0
  v_mfma_f32_16x16x32_bf16 v[244:247], v[148:151], v[152:155], v[244:247]
  ds_read_b64_tr_b16 v[110:111], v94 offset:2048
  ds_read_b64_tr_b16 v[132:133], v12 offset:4096
  ds_read_b64_tr_b16 v[134:135], v12 offset:6144
  v_mfma_f32_16x16x32_bf16 v[232:235], v[156:159], v[172:175], v[232:235]
  ds_read_b64_tr_b16 v[116:117], v11 offset:4096
  ds_read_b64_tr_b16 v[118:119], v11 offset:6144
  ds_read_b64_tr_b16 v[120:121], v92 offset:4096
  v_mfma_f32_16x16x32_bf16 v[236:239], v[160:163], v[172:175], v[236:239]
  ds_read_b64_tr_b16 v[122:123], v92 offset:6144
  ds_read_b64_tr_b16 v[124:125], v93 offset:4096
  ds_read_b64_tr_b16 v[126:127], v93 offset:6144
  v_mfma_f32_16x16x32_bf16 v[240:243], v[164:167], v[172:175], v[240:243]
  ds_read_b64_tr_b16 v[128:129], v94 offset:4096
  ds_read_b64_tr_b16 v[130:131], v94 offset:6144
  v_mfma_f32_16x16x32_bf16 v[244:247], v[168:171], v[172:175], v[244:247]
  v_mov_b32 v192, v184
  v_mov_b32 v193, v185
  v_mov_b32 v194, v186
  v_mov_b32 v195, v187
  v_permlane16_swap_b32 v184, v192
  v_permlane16_swap_b32 v185, v193
  v_permlane16_swap_b32 v186, v194
  v_permlane16_swap_b32 v187, v195
  v_add_f32 v184, v184, v192
  v_add_f32 v185, v185, v193
  v_add_f32 v186, v186, v194
  v_add_f32 v187, v187, v195
  v_mov_b32 v192, v184
  v_mov_b32 v193, v185
  v_mov_b32 v194, v186
  v_mov_b32 v195, v187
  v_permlane32_swap_b32 v184, v192
  v_permlane32_swap_b32 v185, v193
  v_permlane32_swap_b32 v186, v194
  v_permlane32_swap_b32 v187, v195
  v_add_f32 v184, v184, v192
  v_add_f32 v185, v185, v193
  v_add_f32 v186, v186, v194
  v_add_f32 v187, v187, v195
  s_barrier
  s_waitcnt lgkmcnt(0)
  v_add_u32 v11, 49152, v28
  v_add_u32 v12, 57344, v29
  v_xor_b32 v92, 32, v11
  v_xor_b32 v93, 64, v11
  v_xor_b32 v94, 96, v11
  v_mfma_f32_16x16x32_bf16 v[232:235], v[96:99], v[112:115], v[232:235]
  ds_read_b64_tr_b16 v[152:153], v12 offset:0
  ds_read_b64_tr_b16 v[154:155], v12 offset:2048
  ds_read_b64_tr_b16 v[136:137], v11 offset:0
  v_mfma_f32_16x16x32_bf16 v[236:239], v[100:103], v[112:115], v[236:239]
  ds_read_b64_tr_b16 v[138:139], v11 offset:2048
  ds_read_b64_tr_b16 v[140:141], v92 offset:0
  ds_read_b64_tr_b16 v[142:143], v92 offset:2048
  v_mfma_f32_16x16x32_bf16 v[240:243], v[104:107], v[112:115], v[240:243]
  ds_read_b64_tr_b16 v[144:145], v93 offset:0
  ds_read_b64_tr_b16 v[146:147], v93 offset:2048
  ds_read_b64_tr_b16 v[148:149], v94 offset:0
  v_mfma_f32_16x16x32_bf16 v[244:247], v[108:111], v[112:115], v[244:247]
  ds_read_b64_tr_b16 v[150:151], v94 offset:2048
  ds_read_b64_tr_b16 v[172:173], v12 offset:4096
  ds_read_b64_tr_b16 v[174:175], v12 offset:6144
  v_mfma_f32_16x16x32_bf16 v[232:235], v[116:119], v[132:135], v[232:235]
  ds_read_b64_tr_b16 v[156:157], v11 offset:4096
  ds_read_b64_tr_b16 v[158:159], v11 offset:6144
  ds_read_b64_tr_b16 v[160:161], v92 offset:4096
  v_mfma_f32_16x16x32_bf16 v[236:239], v[120:123], v[132:135], v[236:239]
  ds_read_b64_tr_b16 v[162:163], v92 offset:6144
  ds_read_b64_tr_b16 v[164:165], v93 offset:4096
  ds_read_b64_tr_b16 v[166:167], v93 offset:6144
  v_mfma_f32_16x16x32_bf16 v[240:243], v[124:127], v[132:135], v[240:243]
  ds_read_b64_tr_b16 v[168:169], v94 offset:4096
  ds_read_b64_tr_b16 v[170:171], v94 offset:6144
  v_mfma_f32_16x16x32_bf16 v[244:247], v[128:131], v[132:135], v[244:247]
  v_rcp_f32 v184, v184
  v_rcp_f32 v185, v185
  v_rcp_f32 v186, v186
  v_rcp_f32 v187, v187
  v_mul_f32 v176, v176, v184
  v_mul_f32 v180, v180, v184
  v_mul_f32 v177, v177, v185
  v_mul_f32 v181, v181, v185
  v_mul_f32 v178, v178, v186
  v_mul_f32 v182, v182, v186
  v_mul_f32 v179, v179, v187
  v_mul_f32 v183, v183, v187
  v_cvt_pk_bf16_f32 v192, v176, v180
  v_cvt_pk_bf16_f32 v193, v177, v181
  v_cvt_pk_bf16_f32 v194, v178, v182
  v_cvt_pk_bf16_f32 v195, v179, v183
  v_perm_b32 v196, v192, v192, v16
  v_perm_b32 v197, v192, v192, v17
  v_perm_b32 v198, v192, v192, v18
  v_perm_b32 v199, v192, v192, v19
  v_perm_b32 v200, v193, v193, v16
  v_perm_b32 v201, v193, v193, v17
  v_perm_b32 v202, v193, v193, v18
  v_perm_b32 v203, v193, v193, v19
  v_perm_b32 v204, v194, v194, v16
  v_perm_b32 v205, v194, v194, v17
  v_perm_b32 v206, v194, v194, v18
  v_perm_b32 v207, v194, v194, v19
  v_perm_b32 v208, v195, v195, v16
  v_perm_b32 v209, v195, v195, v17
  v_perm_b32 v210, v195, v195, v18
  v_perm_b32 v211, v195, v195, v19
  v_mfma_f32_16x16x32_bf16 v[72:75], v[196:199], v[216:219], 0
  v_mfma_f32_16x16x32_bf16 v[76:79], v[200:203], v[218:221], 0
  v_mfma_f32_16x16x32_bf16 v[80:83], v[204:207], v[220:223], 0
  v_mfma_f32_16x16x32_bf16 v[84:87], v[208:211], v[222:225], 0
  s_barrier
  s_waitcnt lgkmcnt(0)
  v_add_u32 v11, 65536, v28
  v_add_u32 v12, 73728, v29
  v_xor_b32 v92, 32, v11
  v_xor_b32 v93, 64, v11
  v_xor_b32 v94, 96, v11
  v_mfma_f32_16x16x32_bf16 v[232:235], v[136:139], v[152:155], v[232:235]
  ds_read_b64_tr_b16 v[112:113], v12 offset:0
  ds_read_b64_tr_b16 v[114:115], v12 offset:2048
  ds_read_b64_tr_b16 v[96:97], v11 offset:0
  v_mfma_f32_16x16x32_bf16 v[236:239], v[140:143], v[152:155], v[236:239]
  ds_read_b64_tr_b16 v[98:99], v11 offset:2048
  ds_read_b64_tr_b16 v[100:101], v92 offset:0
  ds_read_b64_tr_b16 v[102:103], v92 offset:2048
  v_mfma_f32_16x16x32_bf16 v[240:243], v[144:147], v[152:155], v[240:243]
  ds_read_b64_tr_b16 v[104:105], v93 offset:0
  ds_read_b64_tr_b16 v[106:107], v93 offset:2048
  ds_read_b64_tr_b16 v[108:109], v94 offset:0
  v_mfma_f32_16x16x32_bf16 v[244:247], v[148:151], v[152:155], v[244:247]
  ds_read_b64_tr_b16 v[110:111], v94 offset:2048
  ds_read_b64_tr_b16 v[132:133], v12 offset:4096
  ds_read_b64_tr_b16 v[134:135], v12 offset:6144
  v_mfma_f32_16x16x32_bf16 v[232:235], v[156:159], v[172:175], v[232:235]
  ds_read_b64_tr_b16 v[116:117], v11 offset:4096
  ds_read_b64_tr_b16 v[118:119], v11 offset:6144
  ds_read_b64_tr_b16 v[120:121], v92 offset:4096
  v_mfma_f32_16x16x32_bf16 v[236:239], v[160:163], v[172:175], v[236:239]
  ds_read_b64_tr_b16 v[122:123], v92 offset:6144
  ds_read_b64_tr_b16 v[124:125], v93 offset:4096
  ds_read_b64_tr_b16 v[126:127], v93 offset:6144
  v_mfma_f32_16x16x32_bf16 v[240:243], v[164:167], v[172:175], v[240:243]
  ds_read_b64_tr_b16 v[128:129], v94 offset:4096
  ds_read_b64_tr_b16 v[130:131], v94 offset:6144
  v_mfma_f32_16x16x32_bf16 v[244:247], v[168:171], v[172:175], v[244:247]
  v_cvt_pk_bf16_f32 v176, v72, v73
  v_cvt_pk_bf16_f32 v177, v74, v75
  v_cvt_pk_bf16_f32 v178, v76, v77
  v_cvt_pk_bf16_f32 v179, v78, v79
  v_cvt_pk_bf16_f32 v180, v80, v81
  v_cvt_pk_bf16_f32 v181, v82, v83
  v_cvt_pk_bf16_f32 v182, v84, v85
  v_cvt_pk_bf16_f32 v183, v86, v87
  ds_write_b64 v20, v[176:177] offset:0
  ds_write_b64 v20, v[178:179] offset:32
  ds_write_b64 v20, v[180:181] offset:64
  ds_write_b64 v20, v[182:183] offset:96
  s_waitcnt lgkmcnt(0)
  ds_read_b128 v[176:179], v21
  ds_read_b128 v[180:183], v21 offset:1152
  v_add_u32 v226, 33792, v15
  s_waitcnt lgkmcnt(0)
  buffer_store_dwordx4 v[176:179], v15, s[20:23], 0 offen sc1
  buffer_store_dwordx4 v[180:183], v226, s[20:23], 0 offen sc1
  s_barrier
  s_waitcnt lgkmcnt(0)
  v_add_u32 v11, 81920, v28
  v_add_u32 v12, 16384, v29
  v_xor_b32 v92, 32, v11
  v_xor_b32 v93, 64, v11
  v_xor_b32 v94, 96, v11
  v_mfma_f32_16x16x32_bf16 v[232:235], v[96:99], v[112:115], v[232:235]
  ds_read_b64_tr_b16 v[152:153], v12 offset:0
  ds_read_b64_tr_b16 v[154:155], v12 offset:2048
  ds_read_b64_tr_b16 v[136:137], v11 offset:0
  v_mfma_f32_16x16x32_bf16 v[236:239], v[100:103], v[112:115], v[236:239]
  ds_read_b64_tr_b16 v[138:139], v11 offset:2048
  ds_read_b64_tr_b16 v[140:141], v92 offset:0
  ds_read_b64_tr_b16 v[142:143], v92 offset:2048
  v_mfma_f32_16x16x32_bf16 v[240:243], v[104:107], v[112:115], v[240:243]
  ds_read_b64_tr_b16 v[144:145], v93 offset:0
  ds_read_b64_tr_b16 v[146:147], v93 offset:2048
  ds_read_b64_tr_b16 v[148:149], v94 offset:0
  v_mfma_f32_16x16x32_bf16 v[244:247], v[108:111], v[112:115], v[244:247]
  ds_read_b64_tr_b16 v[150:151], v94 offset:2048
  ds_read_b64_tr_b16 v[172:173], v12 offset:4096
  ds_read_b64_tr_b16 v[174:175], v12 offset:6144
  v_mfma_f32_16x16x32_bf16 v[232:235], v[116:119], v[132:135], v[232:235]
  ds_read_b64_tr_b16 v[156:157], v11 offset:4096
  ds_read_b64_tr_b16 v[158:159], v11 offset:6144
  ds_read_b64_tr_b16 v[160:161], v92 offset:4096
  v_mfma_f32_16x16x32_bf16 v[236:239], v[120:123], v[132:135], v[236:239]
  ds_read_b64_tr_b16 v[162:163], v92 offset:6144
  ds_read_b64_tr_b16 v[164:165], v93 offset:4096
  ds_read_b64_tr_b16 v[166:167], v93 offset:6144
  v_mfma_f32_16x16x32_bf16 v[240:243], v[124:127], v[132:135], v[240:243]
  ds_read_b64_tr_b16 v[168:169], v94 offset:4096
  ds_read_b64_tr_b16 v[170:171], v94 offset:6144
  v_mfma_f32_16x16x32_bf16 v[244:247], v[128:131], v[132:135], v[244:247]
  s_waitcnt vmcnt(0)
  s_mov_b32 s32, s78
  s_mov_b32 s33, s79
  s_mov_b32 s34, 4096
  s_mov_b32 s35, 0x00020000
  s_mov_b32 s36, s80
  s_mov_b32 s37, s81
  s_mov_b32 s38, 2097152
  s_mov_b32 s39, 0x00020000
  s_and_b32 s56, s44, 1
  s_lshr_b32 s57, s44, 1
  v_lshrrev_b32 v2, 5, v1
  v_lshlrev_b32 v2, 3, v2
  v_bfe_u32 v3, v1, 2, 2
  v_add_u32 v2, v2, v3
  v_lshlrev_b32 v5, 7, v2
  v_bfe_u32 v2, v1, 4, 1
  v_lshlrev_b32 v2, 1, v2
  v_bfe_u32 v4, v1, 1, 1
  v_add_u32 v2, v2, v4
  v_lshrrev_b32 v3, 1, v3
  v_lshlrev_b32 v3, 2, v3
  v_xor_b32 v2, v2, v3
  v_and_b32 v4, 1, v1
  v_lshlrev_b32 v4, 3, v4
  v_add_u32 v5, v5, v4
  s_lshl_b32 s52, s56, 2
  v_xor_b32 v3, s52, v2
  v_lshl_add_u32 v4, v3, 4, v5
  s_lshl_b32 s52, s57, 2
  v_xor_b32 v3, s52, v2
  v_lshl_add_u32 v6, v3, 4, v5
  v_mov_b32 v5, v4
  v_and_b32 v2, 31, v1
  s_lshl_b32 s52, s57, 5
  s_add_u32 s52, s52, s101
  v_add_u32 v2, s52, v2
  v_lshlrev_b32 v9, 1, v2
  v_lshlrev_b32 v2, 10, v2
  s_lshl_b32 s52, s56, 5
  s_add_u32 s52, s52, s3
  s_lshl_b32 s52, s52, 1
  v_add_u32 v2, s52, v2
  v_lshrrev_b32 v3, 5, v1
  v_lshl_add_u32 v7, v3, 3, v2
  v_lshl_add_u32 v8, v3, 4, v2
  s_barrier
  s_waitcnt lgkmcnt(0)
  s_cmp_lg_u32 s44, 0
  s_cbranch_scc1 K_post2000
  s_lshl_b32 s52, s94, 2
  s_add_u32 s52, s52, 8192
  v_mov_b32 v2, s52
  v_mov_b32 v3, s51
  s_mov_b64 exec, 1
  buffer_store_dword v3, v2, s[40:43], 0 offen sc1
  s_mov_b64 exec, -1
K_post2000:
  v_add_u32 v11, 90112, v28
  v_add_u32 v12, 0, v29
  v_xor_b32 v92, 32, v11
  v_xor_b32 v93, 64, v11
  v_xor_b32 v94, 96, v11
  v_mfma_f32_16x16x32_bf16 v[232:235], v[136:139], v[152:155], v[232:235]
  ds_read_b64_tr_b16 v[112:113], v12 offset:0
  ds_read_b64_tr_b16 v[114:115], v12 offset:2048
  ds_read_b64_tr_b16 v[96:97], v11 offset:0
  v_mfma_f32_16x16x32_bf16 v[236:239], v[140:143], v[152:155], v[236:239]
  ds_read_b64_tr_b16 v[98:99], v11 offset:2048
  ds_read_b64_tr_b16 v[100:101], v92 offset:0
  ds_read_b64_tr_b16 v[102:103], v92 offset:2048
  v_mfma_f32_16x16x32_bf16 v[240:243], v[144:147], v[152:155], v[240:243]
  ds_read_b64_tr_b16 v[104:105], v93 offset:0
  ds_read_b64_tr_b16 v[106:107], v93 offset:2048
  ds_read_b64_tr_b16 v[108:109], v94 offset:0
  v_mfma_f32_16x16x32_bf16 v[244:247], v[148:151], v[152:155], v[244:247]
  ds_read_b64_tr_b16 v[110:111], v94 offset:2048
  ds_read_b64_tr_b16 v[132:133], v12 offset:4096
  ds_read_b64_tr_b16 v[134:135], v12 offset:6144
  v_mfma_f32_16x16x32_bf16 v[232:235], v[156:159], v[172:175], v[232:235]
  ds_read_b64_tr_b16 v[116:117], v11 offset:4096
  ds_read_b64_tr_b16 v[118:119], v11 offset:6144
  ds_read_b64_tr_b16 v[120:121], v92 offset:4096
  v_mfma_f32_16x16x32_bf16 v[236:239], v[160:163], v[172:175], v[236:239]
  ds_read_b64_tr_b16 v[122:123], v92 offset:6144
  ds_read_b64_tr_b16 v[124:125], v93 offset:4096
  ds_read_b64_tr_b16 v[126:127], v93 offset:6144
  v_mfma_f32_16x16x32_bf16 v[240:243], v[164:167], v[172:175], v[240:243]
  ds_read_b64_tr_b16 v[128:129], v94 offset:4096
  ds_read_b64_tr_b16 v[130:131], v94 offset:6144
  v_mfma_f32_16x16x32_bf16 v[244:247], v[168:171], v[172:175], v[244:247]
  s_barrier
  s_waitcnt lgkmcnt(0)
  v_add_u32 v11, 98304, v28
  v_add_u32 v12, 24576, v29
  v_xor_b32 v92, 32, v11
  v_xor_b32 v93, 64, v11
  v_xor_b32 v94, 96, v11
  v_mfma_f32_16x16x32_bf16 v[232:235], v[96:99], v[112:115], v[232:235]
  ds_read_b64_tr_b16 v[152:153], v12 offset:0
  ds_read_b64_tr_b16 v[154:155], v12 offset:2048
  ds_read_b64_tr_b16 v[136:137], v11 offset:0
  v_mfma_f32_16x16x32_bf16 v[236:239], v[100:103], v[112:115], v[236:239]
  ds_read_b64_tr_b16 v[138:139], v11 offset:2048
  ds_read_b64_tr_b16 v[140:141], v92 offset:0
  ds_read_b64_tr_b16 v[142:143], v92 offset:2048
  v_mfma_f32_16x16x32_bf16 v[240:243], v[104:107], v[112:115], v[240:243]
  ds_read_b64_tr_b16 v[144:145], v93 offset:0
  ds_read_b64_tr_b16 v[146:147], v93 offset:2048
  ds_read_b64_tr_b16 v[148:149], v94 offset:0
  v_mfma_f32_16x16x32_bf16 v[244:247], v[108:111], v[112:115], v[244:247]
  ds_read_b64_tr_b16 v[150:151], v94 offset:2048
  ds_read_b64_tr_b16 v[172:173], v12 offset:4096
  ds_read_b64_tr_b16 v[174:175], v12 offset:6144
  v_mfma_f32_16x16x32_bf16 v[232:235], v[116:119], v[132:135], v[232:235]
  ds_read_b64_tr_b16 v[156:157], v11 offset:4096
  ds_read_b64_tr_b16 v[158:159], v11 offset:6144
  ds_read_b64_tr_b16 v[160:161], v92 offset:4096
  v_mfma_f32_16x16x32_bf16 v[236:239], v[120:123], v[132:135], v[236:239]
  ds_read_b64_tr_b16 v[162:163], v92 offset:6144
  ds_read_b64_tr_b16 v[164:165], v93 offset:4096
  ds_read_b64_tr_b16 v[166:167], v93 offset:6144
  v_mfma_f32_16x16x32_bf16 v[240:243], v[124:127], v[132:135], v[240:243]
  ds_read_b64_tr_b16 v[168:169], v94 offset:4096
  ds_read_b64_tr_b16 v[170:171], v94 offset:6144
  v_mfma_f32_16x16x32_bf16 v[244:247], v[128:131], v[132:135], v[244:247]
  s_barrier
  s_waitcnt lgkmcnt(0)
  v_add_u32 v11, 106496, v28
  v_add_u32 v12, 8192, v29
  v_xor_b32 v92, 32, v11
  v_xor_b32 v93, 64, v11
  v_xor_b32 v94, 96, v11
  v_mfma_f32_16x16x32_bf16 v[232:235], v[136:139], v[152:155], v[232:235]
  ds_read_b64_tr_b16 v[112:113], v12 offset:0
  ds_read_b64_tr_b16 v[114:115], v12 offset:2048
  ds_read_b64_tr_b16 v[96:97], v11 offset:0
  v_mfma_f32_16x16x32_bf16 v[236:239], v[140:143], v[152:155], v[236:239]
  ds_read_b64_tr_b16 v[98:99], v11 offset:2048
  ds_read_b64_tr_b16 v[100:101], v92 offset:0
  ds_read_b64_tr_b16 v[102:103], v92 offset:2048
  v_mfma_f32_16x16x32_bf16 v[240:243], v[144:147], v[152:155], v[240:243]
  ds_read_b64_tr_b16 v[104:105], v93 offset:0
  ds_read_b64_tr_b16 v[106:107], v93 offset:2048
  ds_read_b64_tr_b16 v[108:109], v94 offset:0
  v_mfma_f32_16x16x32_bf16 v[244:247], v[148:151], v[152:155], v[244:247]
  ds_read_b64_tr_b16 v[110:111], v94 offset:2048
  ds_read_b64_tr_b16 v[132:133], v12 offset:4096
  ds_read_b64_tr_b16 v[134:135], v12 offset:6144
  v_mfma_f32_16x16x32_bf16 v[232:235], v[156:159], v[172:175], v[232:235]
  ds_read_b64_tr_b16 v[116:117], v11 offset:4096
  ds_read_b64_tr_b16 v[118:119], v11 offset:6144
  ds_read_b64_tr_b16 v[120:121], v92 offset:4096
  v_mfma_f32_16x16x32_bf16 v[236:239], v[160:163], v[172:175], v[236:239]
  ds_read_b64_tr_b16 v[122:123], v92 offset:6144
  ds_read_b64_tr_b16 v[124:125], v93 offset:4096
  ds_read_b64_tr_b16 v[126:127], v93 offset:6144
  v_mfma_f32_16x16x32_bf16 v[240:243], v[164:167], v[172:175], v[240:243]
  ds_read_b64_tr_b16 v[128:129], v94 offset:4096
  ds_read_b64_tr_b16 v[130:131], v94 offset:6144
  v_mfma_f32_16x16x32_bf16 v[244:247], v[168:171], v[172:175], v[244:247]
  s_barrier
  s_waitcnt lgkmcnt(0)
  v_add_u32 v11, 32768, v28
  v_add_u32 v12, 40960, v29
  v_xor_b32 v92, 32, v11
  v_xor_b32 v93, 64, v11
  v_xor_b32 v94, 96, v11
  v_mfma_f32_16x16x32_bf16 v[232:235], v[96:99], v[112:115], v[232:235]
  ds_read_b64_tr_b16 v[152:153], v12 offset:0
  ds_read_b64_tr_b16 v[154:155], v12 offset:2048
  ds_read_b64_tr_b16 v[136:137], v11 offset:0
  v_mfma_f32_16x16x32_bf16 v[236:239], v[100:103], v[112:115], v[236:239]
  ds_read_b64_tr_b16 v[138:139], v11 offset:2048
  ds_read_b64_tr_b16 v[140:141], v92 offset:0
  ds_read_b64_tr_b16 v[142:143], v92 offset:2048
  v_mfma_f32_16x16x32_bf16 v[240:243], v[104:107], v[112:115], v[240:243]
  ds_read_b64_tr_b16 v[144:145], v93 offset:0
  ds_read_b64_tr_b16 v[146:147], v93 offset:2048
  ds_read_b64_tr_b16 v[148:149], v94 offset:0
  v_mfma_f32_16x16x32_bf16 v[244:247], v[108:111], v[112:115], v[244:247]
  ds_read_b64_tr_b16 v[150:151], v94 offset:2048
  ds_read_b64_tr_b16 v[172:173], v12 offset:4096
  ds_read_b64_tr_b16 v[174:175], v12 offset:6144
  v_mfma_f32_16x16x32_bf16 v[232:235], v[116:119], v[132:135], v[232:235]
  ds_read_b64_tr_b16 v[156:157], v11 offset:4096
  ds_read_b64_tr_b16 v[158:159], v11 offset:6144
  ds_read_b64_tr_b16 v[160:161], v92 offset:4096
  v_mfma_f32_16x16x32_bf16 v[236:239], v[120:123], v[132:135], v[236:239]
  ds_read_b64_tr_b16 v[162:163], v92 offset:6144
  ds_read_b64_tr_b16 v[164:165], v93 offset:4096
  ds_read_b64_tr_b16 v[166:167], v93 offset:6144
  v_mfma_f32_16x16x32_bf16 v[240:243], v[124:127], v[132:135], v[240:243]
  ds_read_b64_tr_b16 v[168:169], v94 offset:4096
  ds_read_b64_tr_b16 v[170:171], v94 offset:6144
  v_mfma_f32_16x16x32_bf16 v[244:247], v[128:131], v[132:135], v[244:247]
  s_barrier
  s_waitcnt lgkmcnt(0)
  v_add_u32 v11, 114688, v28
  v_add_u32 v12, 49152, v29
  v_xor_b32 v92, 32, v11
  v_xor_b32 v93, 64, v11
  v_xor_b32 v94, 96, v11
  v_mfma_f32_16x16x32_bf16 v[232:235], v[136:139], v[152:155], v[232:235]
  ds_read_b64_tr_b16 v[112:113], v12 offset:0
  ds_read_b64_tr_b16 v[114:115], v12 offset:2048
  ds_read_b64_tr_b16 v[96:97], v11 offset:0
  v_mfma_f32_16x16x32_bf16 v[236:239], v[140:143], v[152:155], v[236:239]
  ds_read_b64_tr_b16 v[98:99], v11 offset:2048
  ds_read_b64_tr_b16 v[100:101], v92 offset:0
  ds_read_b64_tr_b16 v[102:103], v92 offset:2048
  v_mfma_f32_16x16x32_bf16 v[240:243], v[144:147], v[152:155], v[240:243]
  ds_read_b64_tr_b16 v[104:105], v93 offset:0
  ds_read_b64_tr_b16 v[106:107], v93 offset:2048
  ds_read_b64_tr_b16 v[108:109], v94 offset:0
  v_mfma_f32_16x16x32_bf16 v[244:247], v[148:151], v[152:155], v[244:247]
  ds_read_b64_tr_b16 v[110:111], v94 offset:2048
  ds_read_b64_tr_b16 v[132:133], v12 offset:4096
  ds_read_b64_tr_b16 v[134:135], v12 offset:6144
  v_mfma_f32_16x16x32_bf16 v[232:235], v[156:159], v[172:175], v[232:235]
  ds_read_b64_tr_b16 v[116:117], v11 offset:4096
  ds_read_b64_tr_b16 v[118:119], v11 offset:6144
  ds_read_b64_tr_b16 v[120:121], v92 offset:4096
  v_mfma_f32_16x16x32_bf16 v[236:239], v[160:163], v[172:175], v[236:239]
  ds_read_b64_tr_b16 v[122:123], v92 offset:6144
  ds_read_b64_tr_b16 v[124:125], v93 offset:4096
  ds_read_b64_tr_b16 v[126:127], v93 offset:6144
  v_mfma_f32_16x16x32_bf16 v[240:243], v[164:167], v[172:175], v[240:243]
  ds_read_b64_tr_b16 v[128:129], v94 offset:4096
  ds_read_b64_tr_b16 v[130:131], v94 offset:6144
  v_mfma_f32_16x16x32_bf16 v[244:247], v[168:171], v[172:175], v[244:247]
  s_barrier
  s_waitcnt lgkmcnt(0)
  v_add_u32 v11, 57344, v28
  v_add_u32 v12, 65536, v29
  v_xor_b32 v92, 32, v11
  v_xor_b32 v93, 64, v11
  v_xor_b32 v94, 96, v11
  v_mfma_f32_16x16x32_bf16 v[232:235], v[96:99], v[112:115], v[232:235]
  ds_read_b64_tr_b16 v[152:153], v12 offset:0
  ds_read_b64_tr_b16 v[154:155], v12 offset:2048
  ds_read_b64_tr_b16 v[136:137], v11 offset:0
  v_mfma_f32_16x16x32_bf16 v[236:239], v[100:103], v[112:115], v[236:239]
  ds_read_b64_tr_b16 v[138:139], v11 offset:2048
  ds_read_b64_tr_b16 v[140:141], v92 offset:0
  ds_read_b64_tr_b16 v[142:143], v92 offset:2048
  v_mfma_f32_16x16x32_bf16 v[240:243], v[104:107], v[112:115], v[240:243]
  ds_read_b64_tr_b16 v[144:145], v93 offset:0
  ds_read_b64_tr_b16 v[146:147], v93 offset:2048
  ds_read_b64_tr_b16 v[148:149], v94 offset:0
  v_mfma_f32_16x16x32_bf16 v[244:247], v[108:111], v[112:115], v[244:247]
  ds_read_b64_tr_b16 v[150:151], v94 offset:2048
  ds_read_b64_tr_b16 v[172:173], v12 offset:4096
  ds_read_b64_tr_b16 v[174:175], v12 offset:6144
  v_mfma_f32_16x16x32_bf16 v[232:235], v[116:119], v[132:135], v[232:235]
  ds_read_b64_tr_b16 v[156:157], v11 offset:4096
  ds_read_b64_tr_b16 v[158:159], v11 offset:6144
  ds_read_b64_tr_b16 v[160:161], v92 offset:4096
  v_mfma_f32_16x16x32_bf16 v[236:239], v[120:123], v[132:135], v[236:239]
  ds_read_b64_tr_b16 v[162:163], v92 offset:6144
  ds_read_b64_tr_b16 v[164:165], v93 offset:4096
  ds_read_b64_tr_b16 v[166:167], v93 offset:6144
  v_mfma_f32_16x16x32_bf16 v[240:243], v[124:127], v[132:135], v[240:243]
  ds_read_b64_tr_b16 v[168:169], v94 offset:4096
  ds_read_b64_tr_b16 v[170:171], v94 offset:6144
  v_mfma_f32_16x16x32_bf16 v[244:247], v[128:131], v[132:135], v[244:247]
  s_barrier
  s_waitcnt lgkmcnt(0)
  v_add_u32 v11, 73728, v28
  v_add_u32 v12, 16384, v29
  v_xor_b32 v92, 32, v11
  v_xor_b32 v93, 64, v11
  v_xor_b32 v94, 96, v11
  v_mfma_f32_16x16x32_bf16 v[232:235], v[136:139], v[152:155], v[232:235]
  ds_read_b64_tr_b16 v[112:113], v12 offset:0
  ds_read_b64_tr_b16 v[114:115], v12 offset:2048
  ds_read_b64_tr_b16 v[96:97], v11 offset:0
  v_mfma_f32_16x16x32_bf16 v[236:239], v[140:143], v[152:155], v[236:239]
  ds_read_b64_tr_b16 v[98:99], v11 offset:2048
  ds_read_b64_tr_b16 v[100:101], v92 offset:0
  ds_read_b64_tr_b16 v[102:103], v92 offset:2048
  v_mfma_f32_16x16x32_bf16 v[240:243], v[144:147], v[152:155], v[240:243]
  ds_read_b64_tr_b16 v[104:105], v93 offset:0
  ds_read_b64_tr_b16 v[106:107], v93 offset:2048
  ds_read_b64_tr_b16 v[108:109], v94 offset:0
  v_mfma_f32_16x16x32_bf16 v[244:247], v[148:151], v[152:155], v[244:247]
  ds_read_b64_tr_b16 v[110:111], v94 offset:2048
  ds_read_b64_tr_b16 v[132:133], v12 offset:4096
  ds_read_b64_tr_b16 v[134:135], v12 offset:6144
  v_mfma_f32_16x16x32_bf16 v[232:235], v[156:159], v[172:175], v[232:235]
  ds_read_b64_tr_b16 v[116:117], v11 offset:4096
  ds_read_b64_tr_b16 v[118:119], v11 offset:6144
  ds_read_b64_tr_b16 v[120:121], v92 offset:4096
  v_mfma_f32_16x16x32_bf16 v[236:239], v[160:163], v[172:175], v[236:239]
  ds_read_b64_tr_b16 v[122:123], v92 offset:6144
  ds_read_b64_tr_b16 v[124:125], v93 offset:4096
  ds_read_b64_tr_b16 v[126:127], v93 offset:6144
  v_mfma_f32_16x16x32_bf16 v[240:243], v[164:167], v[172:175], v[240:243]
  ds_read_b64_tr_b16 v[128:129], v94 offset:4096
  ds_read_b64_tr_b16 v[130:131], v94 offset:6144
  v_mfma_f32_16x16x32_bf16 v[244:247], v[168:171], v[172:175], v[244:247]
  s_barrier
  s_waitcnt lgkmcnt(0)
  s_cmp_lg_u32 s44, 1
  s_cbranch_scc1 K_piO
  v_and_b32 v22, 7, v1
  v_lshlrev_b32 v22, 2, v22
  s_lshl_b32 s52, s100, 5
  s_add_u32 s52, s52, 8192
  v_add_u32 v22, s52, v22
  buffer_load_dword v24, v22, s[40:43], 0 offen sc1
K_piO:
  v_add_u32 v11, 81920, v28
  v_add_u32 v12, 0, v29
  v_xor_b32 v92, 32, v11
  v_xor_b32 v93, 64, v11
  v_xor_b32 v94, 96, v11
  v_mfma_f32_16x16x32_bf16 v[232:235], v[96:99], v[112:115], v[232:235]
  ds_read_b64_tr_b16 v[152:153], v12 offset:0
  ds_read_b64_tr_b16 v[154:155], v12 offset:2048
  ds_read_b64_tr_b16 v[136:137], v11 offset:0
  v_mfma_f32_16x16x32_bf16 v[236:239], v[100:103], v[112:115], v[236:239]
  ds_read_b64_tr_b16 v[138:139], v11 offset:2048
  ds_read_b64_tr_b16 v[140:141], v92 offset:0
  ds_read_b64_tr_b16 v[142:143], v92 offset:2048
  v_mfma_f32_16x16x32_bf16 v[240:243], v[104:107], v[112:115], v[240:243]
  ds_read_b64_tr_b16 v[144:145], v93 offset:0
  ds_read_b64_tr_b16 v[146:147], v93 offset:2048
  ds_read_b64_tr_b16 v[148:149], v94 offset:0
  v_mfma_f32_16x16x32_bf16 v[244:247], v[108:111], v[112:115], v[244:247]
  ds_read_b64_tr_b16 v[150:151], v94 offset:2048
  ds_read_b64_tr_b16 v[172:173], v12 offset:4096
  ds_read_b64_tr_b16 v[174:175], v12 offset:6144
  v_mfma_f32_16x16x32_bf16 v[232:235], v[116:119], v[132:135], v[232:235]
  ds_read_b64_tr_b16 v[156:157], v11 offset:4096
  ds_read_b64_tr_b16 v[158:159], v11 offset:6144
  ds_read_b64_tr_b16 v[160:161], v92 offset:4096
  v_mfma_f32_16x16x32_bf16 v[236:239], v[120:123], v[132:135], v[236:239]
  ds_read_b64_tr_b16 v[162:163], v92 offset:6144
  ds_read_b64_tr_b16 v[164:165], v93 offset:4096
  ds_read_b64_tr_b16 v[166:167], v93 offset:6144
  v_mfma_f32_16x16x32_bf16 v[240:243], v[124:127], v[132:135], v[240:243]
  ds_read_b64_tr_b16 v[168:169], v94 offset:4096
  ds_read_b64_tr_b16 v[170:171], v94 offset:6144
  v_mfma_f32_16x16x32_bf16 v[244:247], v[128:131], v[132:135], v[244:247]
  s_barrier
  s_waitcnt lgkmcnt(0)
  v_add_u32 v11, 90112, v28
  v_add_u32 v12, 24576, v29
  v_xor_b32 v92, 32, v11
  v_xor_b32 v93, 64, v11
  v_xor_b32 v94, 96, v11
  v_mfma_f32_16x16x32_bf16 v[232:235], v[136:139], v[152:155], v[232:235]
  ds_read_b64_tr_b16 v[112:113], v12 offset:0
  ds_read_b64_tr_b16 v[114:115], v12 offset:2048
  ds_read_b64_tr_b16 v[96:97], v11 offset:0
  v_mfma_f32_16x16x32_bf16 v[236:239], v[140:143], v[152:155], v[236:239]
  ds_read_b64_tr_b16 v[98:99], v11 offset:2048
  ds_read_b64_tr_b16 v[100:101], v92 offset:0
  ds_read_b64_tr_b16 v[102:103], v92 offset:2048
  v_mfma_f32_16x16x32_bf16 v[240:243], v[144:147], v[152:155], v[240:243]
  ds_read_b64_tr_b16 v[104:105], v93 offset:0
  ds_read_b64_tr_b16 v[106:107], v93 offset:2048
  ds_read_b64_tr_b16 v[108:109], v94 offset:0
  v_mfma_f32_16x16x32_bf16 v[244:247], v[148:151], v[152:155], v[244:247]
  ds_read_b64_tr_b16 v[110:111], v94 offset:2048
  ds_read_b64_tr_b16 v[132:133], v12 offset:4096
  ds_read_b64_tr_b16 v[134:135], v12 offset:6144
  v_mfma_f32_16x16x32_bf16 v[232:235], v[156:159], v[172:175], v[232:235]
  ds_read_b64_tr_b16 v[116:117], v11 offset:4096
  ds_read_b64_tr_b16 v[118:119], v11 offset:6144
  ds_read_b64_tr_b16 v[120:121], v92 offset:4096
  v_mfma_f32_16x16x32_bf16 v[236:239], v[160:163], v[172:175], v[236:239]
  ds_read_b64_tr_b16 v[122:123], v92 offset:6144
  ds_read_b64_tr_b16 v[124:125], v93 offset:4096
  ds_read_b64_tr_b16 v[126:127], v93 offset:6144
  v_mfma_f32_16x16x32_bf16 v[240:243], v[164:167], v[172:175], v[240:243]
  ds_read_b64_tr_b16 v[128:129], v94 offset:4096
  ds_read_b64_tr_b16 v[130:131], v94 offset:6144
  v_mfma_f32_16x16x32_bf16 v[244:247], v[168:171], v[172:175], v[244:247]
  s_cmp_lg_u32 s44, 1
  s_cbranch_scc1 K_pdO
  s_mov_b32 s53, 0
K_plO:
  s_waitcnt vmcnt(0)
  v_cmp_ne_u32 vcc, s51, v24
  s_nop 4
  s_cbranch_vccz K_pdO
  s_add_u32 s53, s53, 1
  s_cmp_lt_u32 s53, 0x80000
  s_cbranch_scc0 K_pdO
  buffer_load_dword v24, v22, s[40:43], 0 offen sc1
  s_branch K_plO
K_pdO:
  s_barrier
  s_waitcnt lgkmcnt(0)
  v_add_u32 v11, 98304, v28
  v_add_u32 v12, 8192, v29
  v_xor_b32 v92, 32, v11
  v_xor_b32 v93, 64, v11
  v_xor_b32 v94, 96, v11
  v_mfma_f32_16x16x32_bf16 v[232:235], v[96:99], v[112:115], v[232:235]
  ds_read_b64_tr_b16 v[152:153], v12 offset:0
  ds_read_b64_tr_b16 v[154:155], v12 offset:2048
  ds_read_b64_tr_b16 v[136:137], v11 offset:0
  v_mfma_f32_16x16x32_bf16 v[236:239], v[100:103], v[112:115], v[236:239]
  ds_read_b64_tr_b16 v[138:139], v11 offset:2048
  ds_read_b64_tr_b16 v[140:141], v92 offset:0
  ds_read_b64_tr_b16 v[142:143], v92 offset:2048
  v_mfma_f32_16x16x32_bf16 v[240:243], v[104:107], v[112:115], v[240:243]
  ds_read_b64_tr_b16 v[144:145], v93 offset:0
  ds_read_b64_tr_b16 v[146:147], v93 offset:2048
  ds_read_b64_tr_b16 v[148:149], v94 offset:0
  v_mfma_f32_16x16x32_bf16 v[244:247], v[108:111], v[112:115], v[244:247]
  ds_read_b64_tr_b16 v[150:151], v94 offset:2048
  ds_read_b64_tr_b16 v[172:173], v12 offset:4096
  ds_read_b64_tr_b16 v[174:175], v12 offset:6144
  v_mfma_f32_16x16x32_bf16 v[232:235], v[116:119], v[132:135], v[232:235]
  ds_read_b64_tr_b16 v[156:157], v11 offset:4096
  ds_read_b64_tr_b16 v[158:159], v11 offset:6144
  ds_read_b64_tr_b16 v[160:161], v92 offset:4096
  v_mfma_f32_16x16x32_bf16 v[236:239], v[120:123], v[132:135], v[236:239]
  ds_read_b64_tr_b16 v[162:163], v92 offset:6144
  ds_read_b64_tr_b16 v[164:165], v93 offset:4096
  ds_read_b64_tr_b16 v[166:167], v93 offset:6144
  v_mfma_f32_16x16x32_bf16 v[240:243], v[124:127], v[132:135], v[240:243]
  ds_read_b64_tr_b16 v[168:169], v94 offset:4096
  ds_read_b64_tr_b16 v[170:171], v94 offset:6144
  v_mfma_f32_16x16x32_bf16 v[244:247], v[128:131], v[132:135], v[244:247]
  s_barrier
  s_waitcnt lgkmcnt(0)
  v_add_u32 v11, 106496, v28
  v_add_u32 v12, 32768, v29
  v_xor_b32 v92, 32, v11
  v_xor_b32 v93, 64, v11
  v_xor_b32 v94, 96, v11
  v_mfma_f32_16x16x32_bf16 v[232:235], v[136:139], v[152:155], v[232:235]
  ds_read_b64_tr_b16 v[112:113], v12 offset:0
  ds_read_b64_tr_b16 v[114:115], v12 offset:2048
  ds_read_b64_tr_b16 v[96:97], v11 offset:0
  v_mfma_f32_16x16x32_bf16 v[236:239], v[140:143], v[152:155], v[236:239]
  ds_read_b64_tr_b16 v[98:99], v11 offset:2048
  ds_read_b64_tr_b16 v[100:101], v92 offset:0
  ds_read_b64_tr_b16 v[102:103], v92 offset:2048
  v_mfma_f32_16x16x32_bf16 v[240:243], v[144:147], v[152:155], v[240:243]
  ds_read_b64_tr_b16 v[104:105], v93 offset:0
  ds_read_b64_tr_b16 v[106:107], v93 offset:2048
  ds_read_b64_tr_b16 v[108:109], v94 offset:0
  v_mfma_f32_16x16x32_bf16 v[244:247], v[148:151], v[152:155], v[244:247]
  ds_read_b64_tr_b16 v[110:111], v94 offset:2048
  ds_read_b64_tr_b16 v[132:133], v12 offset:4096
  ds_read_b64_tr_b16 v[134:135], v12 offset:6144
  v_mfma_f32_16x16x32_bf16 v[232:235], v[156:159], v[172:175], v[232:235]
  ds_read_b64_tr_b16 v[116:117], v11 offset:4096
  ds_read_b64_tr_b16 v[118:119], v11 offset:6144
  ds_read_b64_tr_b16 v[120:121], v92 offset:4096
  v_mfma_f32_16x16x32_bf16 v[236:239], v[160:163], v[172:175], v[236:239]
  ds_read_b64_tr_b16 v[122:123], v92 offset:6144
  ds_read_b64_tr_b16 v[124:125], v93 offset:4096
  ds_read_b64_tr_b16 v[126:127], v93 offset:6144
  v_mfma_f32_16x16x32_bf16 v[240:243], v[164:167], v[172:175], v[240:243]
  ds_read_b64_tr_b16 v[128:129], v94 offset:4096
  ds_read_b64_tr_b16 v[130:131], v94 offset:6144
  v_mfma_f32_16x16x32_bf16 v[244:247], v[168:171], v[172:175], v[244:247]
  s_barrier
  s_waitcnt lgkmcnt(0)
  v_add_u32 v11, 40960, v28
  v_add_u32 v12, 49152, v29
  v_xor_b32 v92, 32, v11
  v_xor_b32 v93, 64, v11
  v_xor_b32 v94, 96, v11
  v_mfma_f32_16x16x32_bf16 v[232:235], v[96:99], v[112:115], v[232:235]
  ds_read_b64_tr_b16 v[152:153], v12 offset:0
  ds_read_b64_tr_b16 v[154:155], v12 offset:2048
  ds_read_b64_tr_b16 v[136:137], v11 offset:0
  v_mfma_f32_16x16x32_bf16 v[236:239], v[100:103], v[112:115], v[236:239]
  ds_read_b64_tr_b16 v[138:139], v11 offset:2048
  ds_read_b64_tr_b16 v[140:141], v92 offset:0
  ds_read_b64_tr_b16 v[142:143], v92 offset:2048
  v_mfma_f32_16x16x32_bf16 v[240:243], v[104:107], v[112:115], v[240:243]
  ds_read_b64_tr_b16 v[144:145], v93 offset:0
  ds_read_b64_tr_b16 v[146:147], v93 offset:2048
  ds_read_b64_tr_b16 v[148:149], v94 offset:0
  v_mfma_f32_16x16x32_bf16 v[244:247], v[108:111], v[112:115], v[244:247]
  ds_read_b64_tr_b16 v[150:151], v94 offset:2048
  ds_read_b64_tr_b16 v[172:173], v12 offset:4096
  ds_read_b64_tr_b16 v[174:175], v12 offset:6144
  v_mfma_f32_16x16x32_bf16 v[232:235], v[116:119], v[132:135], v[232:235]
  ds_read_b64_tr_b16 v[156:157], v11 offset:4096
  ds_read_b64_tr_b16 v[158:159], v11 offset:6144
  ds_read_b64_tr_b16 v[160:161], v92 offset:4096
  v_mfma_f32_16x16x32_bf16 v[236:239], v[120:123], v[132:135], v[236:239]
  ds_read_b64_tr_b16 v[162:163], v92 offset:6144
  ds_read_b64_tr_b16 v[164:165], v93 offset:4096
  ds_read_b64_tr_b16 v[166:167], v93 offset:6144
  v_mfma_f32_16x16x32_bf16 v[240:243], v[124:127], v[132:135], v[240:243]
  ds_read_b64_tr_b16 v[168:169], v94 offset:4096
  ds_read_b64_tr_b16 v[170:171], v94 offset:6144
  v_mfma_f32_16x16x32_bf16 v[244:247], v[128:131], v[132:135], v[244:247]
  s_barrier
  s_waitcnt lgkmcnt(0)
  v_add_u32 v11, 114688, v28
  v_add_u32 v12, 57344, v29
  v_xor_b32 v92, 32, v11
  v_xor_b32 v93, 64, v11
  v_xor_b32 v94, 96, v11
  v_mfma_f32_16x16x32_bf16 v[232:235], v[136:139], v[152:155], v[232:235]
  ds_read_b64_tr_b16 v[112:113], v12 offset:0
  ds_read_b64_tr_b16 v[114:115], v12 offset:2048
  ds_read_b64_tr_b16 v[96:97], v11 offset:0
  v_mfma_f32_16x16x32_bf16 v[236:239], v[140:143], v[152:155], v[236:239]
  ds_read_b64_tr_b16 v[98:99], v11 offset:2048
  ds_read_b64_tr_b16 v[100:101], v92 offset:0
  ds_read_b64_tr_b16 v[102:103], v92 offset:2048
  v_mfma_f32_16x16x32_bf16 v[240:243], v[144:147], v[152:155], v[240:243]
  ds_read_b64_tr_b16 v[104:105], v93 offset:0
  ds_read_b64_tr_b16 v[106:107], v93 offset:2048
  ds_read_b64_tr_b16 v[108:109], v94 offset:0
  v_mfma_f32_16x16x32_bf16 v[244:247], v[148:151], v[152:155], v[244:247]
  ds_read_b64_tr_b16 v[110:111], v94 offset:2048
  ds_read_b64_tr_b16 v[132:133], v12 offset:4096
  ds_read_b64_tr_b16 v[134:135], v12 offset:6144
  v_mfma_f32_16x16x32_bf16 v[232:235], v[156:159], v[172:175], v[232:235]
  ds_read_b64_tr_b16 v[116:117], v11 offset:4096
  ds_read_b64_tr_b16 v[118:119], v11 offset:6144
  ds_read_b64_tr_b16 v[120:121], v92 offset:4096
  v_mfma_f32_16x16x32_bf16 v[236:239], v[160:163], v[172:175], v[236:239]
  ds_read_b64_tr_b16 v[122:123], v92 offset:6144
  ds_read_b64_tr_b16 v[124:125], v93 offset:4096
  ds_read_b64_tr_b16 v[126:127], v93 offset:6144
  v_mfma_f32_16x16x32_bf16 v[240:243], v[164:167], v[172:175], v[240:243]
  ds_read_b64_tr_b16 v[128:129], v94 offset:4096
  ds_read_b64_tr_b16 v[130:131], v94 offset:6144
  v_mfma_f32_16x16x32_bf16 v[244:247], v[168:171], v[172:175], v[244:247]
  s_barrier
  s_waitcnt lgkmcnt(0)
  v_add_u32 v11, 65536, v28
  v_add_u32 v12, 16384, v29
  v_xor_b32 v92, 32, v11
  v_xor_b32 v93, 64, v11
  v_xor_b32 v94, 96, v11
  v_mfma_f32_16x16x32_bf16 v[232:235], v[96:99], v[112:115], v[232:235]
  ds_read_b64_tr_b16 v[152:153], v12 offset:0
  ds_read_b64_tr_b16 v[154:155], v12 offset:2048
  ds_read_b64_tr_b16 v[136:137], v11 offset:0
  v_mfma_f32_16x16x32_bf16 v[236:239], v[100:103], v[112:115], v[236:239]
  ds_read_b64_tr_b16 v[138:139], v11 offset:2048
  ds_read_b64_tr_b16 v[140:141], v92 offset:0
  ds_read_b64_tr_b16 v[142:143], v92 offset:2048
  v_mfma_f32_16x16x32_bf16 v[240:243], v[104:107], v[112:115], v[240:243]
  ds_read_b64_tr_b16 v[144:145], v93 offset:0
  ds_read_b64_tr_b16 v[146:147], v93 offset:2048
  ds_read_b64_tr_b16 v[148:149], v94 offset:0
  v_mfma_f32_16x16x32_bf16 v[244:247], v[108:111], v[112:115], v[244:247]
  ds_read_b64_tr_b16 v[150:151], v94 offset:2048
  ds_read_b64_tr_b16 v[172:173], v12 offset:4096
  ds_read_b64_tr_b16 v[174:175], v12 offset:6144
  v_mfma_f32_16x16x32_bf16 v[232:235], v[116:119], v[132:135], v[232:235]
  ds_read_b64_tr_b16 v[156:157], v11 offset:4096
  ds_read_b64_tr_b16 v[158:159], v11 offset:6144
  ds_read_b64_tr_b16 v[160:161], v92 offset:4096
  v_mfma_f32_16x16x32_bf16 v[236:239], v[120:123], v[132:135], v[236:239]
  ds_read_b64_tr_b16 v[162:163], v92 offset:6144
  ds_read_b64_tr_b16 v[164:165], v93 offset:4096
  ds_read_b64_tr_b16 v[166:167], v93 offset:6144
  v_mfma_f32_16x16x32_bf16 v[240:243], v[124:127], v[132:135], v[240:243]
  ds_read_b64_tr_b16 v[168:169], v94 offset:4096
  ds_read_b64_tr_b16 v[170:171], v94 offset:6144
  v_mfma_f32_16x16x32_bf16 v[244:247], v[128:131], v[132:135], v[244:247]
  s_barrier
  s_waitcnt lgkmcnt(0)
  v_add_u32 v11, 73728, v28
  v_add_u32 v12, 0, v29
  v_xor_b32 v92, 32, v11
  v_xor_b32 v93, 64, v11
  v_xor_b32 v94, 96, v11
  v_mfma_f32_16x16x32_bf16 v[232:235], v[136:139], v[152:155], v[232:235]
  ds_read_b64_tr_b16 v[112:113], v12 offset:0
  ds_read_b64_tr_b16 v[114:115], v12 offset:2048
  ds_read_b64_tr_b16 v[96:97], v11 offset:0
  v_mfma_f32_16x16x32_bf16 v[236:239], v[140:143], v[152:155], v[236:239]
  ds_read_b64_tr_b16 v[98:99], v11 offset:2048
  ds_read_b64_tr_b16 v[100:101], v92 offset:0
  ds_read_b64_tr_b16 v[102:103], v92 offset:2048
  v_mfma_f32_16x16x32_bf16 v[240:243], v[144:147], v[152:155], v[240:243]
  ds_read_b64_tr_b16 v[104:105], v93 offset:0
  ds_read_b64_tr_b16 v[106:107], v93 offset:2048
  ds_read_b64_tr_b16 v[108:109], v94 offset:0
  v_mfma_f32_16x16x32_bf16 v[244:247], v[148:151], v[152:155], v[244:247]
  ds_read_b64_tr_b16 v[110:111], v94 offset:2048
  ds_read_b64_tr_b16 v[132:133], v12 offset:4096
  ds_read_b64_tr_b16 v[134:135], v12 offset:6144
  v_mfma_f32_16x16x32_bf16 v[232:235], v[156:159], v[172:175], v[232:235]
  ds_read_b64_tr_b16 v[116:117], v11 offset:4096
  ds_read_b64_tr_b16 v[118:119], v11 offset:6144
  ds_read_b64_tr_b16 v[120:121], v92 offset:4096
  v_mfma_f32_16x16x32_bf16 v[236:239], v[160:163], v[172:175], v[236:239]
  ds_read_b64_tr_b16 v[122:123], v92 offset:6144
  ds_read_b64_tr_b16 v[124:125], v93 offset:4096
  ds_read_b64_tr_b16 v[126:127], v93 offset:6144
  v_mfma_f32_16x16x32_bf16 v[240:243], v[164:167], v[172:175], v[240:243]
  ds_read_b64_tr_b16 v[128:129], v94 offset:4096
  ds_read_b64_tr_b16 v[130:131], v94 offset:6144
  v_mfma_f32_16x16x32_bf16 v[244:247], v[168:171], v[172:175], v[244:247]
  s_barrier
  s_waitcnt lgkmcnt(0)
  v_add_u32 v11, 81920, v28
  v_add_u32 v12, 24576, v29
  v_xor_b32 v92, 32, v11
  v_xor_b32 v93, 64, v11
  v_xor_b32 v94, 96, v11
  v_mfma_f32_16x16x32_bf16 v[232:235], v[96:99], v[112:115], v[232:235]
  ds_read_b64_tr_b16 v[152:153], v12 offset:0
  ds_read_b64_tr_b16 v[154:155], v12 offset:2048
  ds_read_b64_tr_b16 v[136:137], v11 offset:0
  v_mfma_f32_16x16x32_bf16 v[236:239], v[100:103], v[112:115], v[236:239]
  ds_read_b64_tr_b16 v[138:139], v11 offset:2048
  ds_read_b64_tr_b16 v[140:141], v92 offset:0
  ds_read_b64_tr_b16 v[142:143], v92 offset:2048
  v_mfma_f32_16x16x32_bf16 v[240:243], v[104:107], v[112:115], v[240:243]
  ds_read_b64_tr_b16 v[144:145], v93 offset:0
  ds_read_b64_tr_b16 v[146:147], v93 offset:2048
  ds_read_b64_tr_b16 v[148:149], v94 offset:0
  v_mfma_f32_16x16x32_bf16 v[244:247], v[108:111], v[112:115], v[244:247]
  ds_read_b64_tr_b16 v[150:151], v94 offset:2048
  ds_read_b64_tr_b16 v[172:173], v12 offset:4096
  ds_read_b64_tr_b16 v[174:175], v12 offset:6144
  v_mfma_f32_16x16x32_bf16 v[232:235], v[116:119], v[132:135], v[232:235]
  ds_read_b64_tr_b16 v[156:157], v11 offset:4096
  ds_read_b64_tr_b16 v[158:159], v11 offset:6144
  ds_read_b64_tr_b16 v[160:161], v92 offset:4096
  v_mfma_f32_16x16x32_bf16 v[236:239], v[120:123], v[132:135], v[236:239]
  ds_read_b64_tr_b16 v[162:163], v92 offset:6144
  ds_read_b64_tr_b16 v[164:165], v93 offset:4096
  ds_read_b64_tr_b16 v[166:167], v93 offset:6144
  v_mfma_f32_16x16x32_bf16 v[240:243], v[124:127], v[132:135], v[240:243]
  ds_read_b64_tr_b16 v[168:169], v94 offset:4096
  ds_read_b64_tr_b16 v[170:171], v94 offset:6144
  v_mfma_f32_16x16x32_bf16 v[244:247], v[128:131], v[132:135], v[244:247]
  s_barrier
  s_waitcnt lgkmcnt(0)
  v_add_u32 v11, 90112, v28
  v_add_u32 v12, 8192, v29
  v_xor_b32 v92, 32, v11
  v_xor_b32 v93, 64, v11
  v_xor_b32 v94, 96, v11
  v_mfma_f32_16x16x32_bf16 v[232:235], v[136:139], v[152:155], v[232:235]
  ds_read_b64_tr_b16 v[112:113], v12 offset:0
  ds_read_b64_tr_b16 v[114:115], v12 offset:2048
  ds_read_b64_tr_b16 v[96:97], v11 offset:0
  v_mfma_f32_16x16x32_bf16 v[236:239], v[140:143], v[152:155], v[236:239]
  ds_read_b64_tr_b16 v[98:99], v11 offset:2048
  ds_read_b64_tr_b16 v[100:101], v92 offset:0
  ds_read_b64_tr_b16 v[102:103], v92 offset:2048
  v_mfma_f32_16x16x32_bf16 v[240:243], v[144:147], v[152:155], v[240:243]
  ds_read_b64_tr_b16 v[104:105], v93 offset:0
  ds_read_b64_tr_b16 v[106:107], v93 offset:2048
  ds_read_b64_tr_b16 v[108:109], v94 offset:0
  v_mfma_f32_16x16x32_bf16 v[244:247], v[148:151], v[152:155], v[244:247]
  ds_read_b64_tr_b16 v[110:111], v94 offset:2048
  ds_read_b64_tr_b16 v[132:133], v12 offset:4096
  ds_read_b64_tr_b16 v[134:135], v12 offset:6144
  v_mfma_f32_16x16x32_bf16 v[232:235], v[156:159], v[172:175], v[232:235]
  ds_read_b64_tr_b16 v[116:117], v11 offset:4096
  ds_read_b64_tr_b16 v[118:119], v11 offset:6144
  ds_read_b64_tr_b16 v[120:121], v92 offset:4096
  v_mfma_f32_16x16x32_bf16 v[236:239], v[160:163], v[172:175], v[236:239]
  ds_read_b64_tr_b16 v[122:123], v92 offset:6144
  ds_read_b64_tr_b16 v[124:125], v93 offset:4096
  ds_read_b64_tr_b16 v[126:127], v93 offset:6144
  v_mfma_f32_16x16x32_bf16 v[240:243], v[164:167], v[172:175], v[240:243]
  ds_read_b64_tr_b16 v[128:129], v94 offset:4096
  ds_read_b64_tr_b16 v[130:131], v94 offset:6144
  v_mfma_f32_16x16x32_bf16 v[244:247], v[168:171], v[172:175], v[244:247]
  s_barrier
  s_waitcnt lgkmcnt(0)
  v_add_u32 v11, 98304, v28
  v_add_u32 v12, 32768, v29
  v_xor_b32 v92, 32, v11
  v_xor_b32 v93, 64, v11
  v_xor_b32 v94, 96, v11
  v_mfma_f32_16x16x32_bf16 v[232:235], v[96:99], v[112:115], v[232:235]
  ds_read_b64_tr_b16 v[152:153], v12 offset:0
  ds_read_b64_tr_b16 v[154:155], v12 offset:2048
  ds_read_b64_tr_b16 v[136:137], v11 offset:0
  v_mfma_f32_16x16x32_bf16 v[236:239], v[100:103], v[112:115], v[236:239]
  ds_read_b64_tr_b16 v[138:139], v11 offset:2048
  ds_read_b64_tr_b16 v[140:141], v92 offset:0
  ds_read_b64_tr_b16 v[142:143], v92 offset:2048
  v_mfma_f32_16x16x32_bf16 v[240:243], v[104:107], v[112:115], v[240:243]
  ds_read_b64_tr_b16 v[144:145], v93 offset:0
  ds_read_b64_tr_b16 v[146:147], v93 offset:2048
  ds_read_b64_tr_b16 v[148:149], v94 offset:0
  v_mfma_f32_16x16x32_bf16 v[244:247], v[108:111], v[112:115], v[244:247]
  ds_read_b64_tr_b16 v[150:151], v94 offset:2048
  ds_read_b64_tr_b16 v[172:173], v12 offset:4096
  ds_read_b64_tr_b16 v[174:175], v12 offset:6144
  v_mfma_f32_16x16x32_bf16 v[232:235], v[116:119], v[132:135], v[232:235]
  ds_read_b64_tr_b16 v[156:157], v11 offset:4096
  ds_read_b64_tr_b16 v[158:159], v11 offset:6144
  ds_read_b64_tr_b16 v[160:161], v92 offset:4096
  v_mfma_f32_16x16x32_bf16 v[236:239], v[120:123], v[132:135], v[236:239]
  ds_read_b64_tr_b16 v[162:163], v92 offset:6144
  ds_read_b64_tr_b16 v[164:165], v93 offset:4096
  ds_read_b64_tr_b16 v[166:167], v93 offset:6144
  v_mfma_f32_16x16x32_bf16 v[240:243], v[124:127], v[132:135], v[240:243]
  ds_read_b64_tr_b16 v[168:169], v94 offset:4096
  ds_read_b64_tr_b16 v[170:171], v94 offset:6144
  v_mfma_f32_16x16x32_bf16 v[244:247], v[128:131], v[132:135], v[244:247]
  s_barrier
  s_waitcnt lgkmcnt(0)
  v_mfma_f32_16x16x32_bf16 v[232:235], v[136:139], v[152:155], v[232:235]
  v_mfma_f32_16x16x32_bf16 v[236:239], v[140:143], v[152:155], v[236:239]
  v_mfma_f32_16x16x32_bf16 v[240:243], v[144:147], v[152:155], v[240:243]
  v_mfma_f32_16x16x32_bf16 v[244:247], v[148:151], v[152:155], v[244:247]
  v_mfma_f32_16x16x32_bf16 v[232:235], v[156:159], v[172:175], v[232:235]
  v_mfma_f32_16x16x32_bf16 v[236:239], v[160:163], v[172:175], v[236:239]
  v_mfma_f32_16x16x32_bf16 v[240:243], v[164:167], v[172:175], v[240:243]
  v_mfma_f32_16x16x32_bf16 v[244:247], v[168:171], v[172:175], v[244:247]
  v_lshlrev_b32 v31, 16, v31
  s_mov_b32 s92, 0xc0135761
  s_mov_b32 s93, 0xbdd2d3e8
  v_mov_b32 v4, s92
  s_nop 0
  v_add_f32 v232, v232, v31
  v_add_f32 v233, v233, v31
  v_add_f32 v234, v234, v31
  v_add_f32 v235, v235, v31
  v_add_f32 v236, v236, v31
  v_add_f32 v237, v237, v31
  v_add_f32 v238, v238, v31
  v_add_f32 v239, v239, v31
  v_add_f32 v240, v240, v31
  v_add_f32 v241, v241, v31
  v_add_f32 v242, v242, v31
  v_add_f32 v243, v243, v31
  v_add_f32 v244, v244, v31
  v_add_f32 v245, v245, v31
  v_add_f32 v246, v246, v31
  v_add_f32 v247, v247, v31
  v_mul_f32 v176, v232, v232
  v_mul_f32 v177, v233, v233
  v_mul_f32 v178, v234, v234
  v_mul_f32 v179, v235, v235
  v_mul_f32 v180, v236, v236
  v_mul_f32 v181, v237, v237
  v_mul_f32 v182, v238, v238
  v_mul_f32 v183, v239, v239
  v_mul_f32 v184, v240, v240
  v_mul_f32 v185, v241, v241
  v_mul_f32 v186, v242, v242
  v_mul_f32 v187, v243, v243
  v_mul_f32 v188, v244, v244
  v_mul_f32 v189, v245, v245
  v_mul_f32 v190, v246, v246
  v_mul_f32 v191, v247, v247
  v_fma_f32 v176, v176, s93, v4
  v_fma_f32 v177, v177, s93, v4
  v_fma_f32 v178, v178, s93, v4
  v_fma_f32 v179, v179, s93, v4
  v_fma_f32 v180, v180, s93, v4
  v_fma_f32 v181, v181, s93, v4
  v_fma_f32 v182, v182, s93, v4
  v_fma_f32 v183, v183, s93, v4
  v_fma_f32 v184, v184, s93, v4
  v_fma_f32 v185, v185, s93, v4
  v_fma_f32 v186, v186, s93, v4
  v_fma_f32 v187, v187, s93, v4
  v_fma_f32 v188, v188, s93, v4
  v_fma_f32 v189, v189, s93, v4
  v_fma_f32 v190, v190, s93, v4
  v_fma_f32 v191, v191, s93, v4
  v_mul_f32 v176, v176, v232
  v_mul_f32 v177, v177, v233
  v_mul_f32 v178, v178, v234
  v_mul_f32 v179, v179, v235
  v_mul_f32 v180, v180, v236
  v_mul_f32 v181, v181, v237
  v_mul_f32 v182, v182, v238
  v_mul_f32 v183, v183, v239
  v_mul_f32 v184, v184, v240
  v_mul_f32 v185, v185, v241
  v_mul_f32 v186, v186, v242
  v_mul_f32 v187, v187, v243
  v_mul_f32 v188, v188, v244
  v_mul_f32 v189, v189, v245
  v_mul_f32 v190, v190, v246
  v_mul_f32 v191, v191, v247
  v_exp_f32 v176, v176
  v_exp_f32 v177, v177
  v_exp_f32 v178, v178
  v_exp_f32 v179, v179
  v_exp_f32 v180, v180
  v_exp_f32 v181, v181
  v_exp_f32 v182, v182
  v_exp_f32 v183, v183
  v_exp_f32 v184, v184
  v_exp_f32 v185, v185
  v_exp_f32 v186, v186
  v_exp_f32 v187, v187
  v_exp_f32 v188, v188
  v_exp_f32 v189, v189
  v_exp_f32 v190, v190
  v_exp_f32 v191, v191
  v_add_f32 v176, 1.0, v176
  v_add_f32 v177, 1.0, v177
  v_add_f32 v178, 1.0, v178
  v_add_f32 v179, 1.0, v179
  v_add_f32 v180, 1.0, v180
  v_add_f32 v181, 1.0, v181
  v_add_f32 v182, 1.0, v182
  v_add_f32 v183, 1.0, v183
  v_add_f32 v184, 1.0, v184
  v_add_f32 v185, 1.0, v185
  v_add_f32 v186, 1.0, v186
  v_add_f32 v187, 1.0, v187
  v_add_f32 v188, 1.0, v188
  v_add_f32 v189, 1.0, v189
  v_add_f32 v190, 1.0, v190
  v_add_f32 v191, 1.0, v191
  v_rcp_f32 v176, v176
  v_rcp_f32 v177, v177
  v_rcp_f32 v178, v178
  v_rcp_f32 v179, v179
  v_rcp_f32 v180, v180
  v_rcp_f32 v181, v181
  v_rcp_f32 v182, v182
  v_rcp_f32 v183, v183
  v_rcp_f32 v184, v184
  v_rcp_f32 v185, v185
  v_rcp_f32 v186, v186
  v_rcp_f32 v187, v187
  v_rcp_f32 v188, v188
  v_rcp_f32 v189, v189
  v_rcp_f32 v190, v190
  v_rcp_f32 v191, v191
  v_mul_f32 v232, v232, v176
  v_mul_f32 v233, v233, v177
  v_mul_f32 v234, v234, v178
  v_mul_f32 v235, v235, v179
  v_mul_f32 v236, v236, v180
  v_mul_f32 v237, v237, v181
  v_mul_f32 v238, v238, v182
  v_mul_f32 v239, v239, v183
  v_mul_f32 v240, v240, v184
  v_mul_f32 v241, v241, v185
  v_mul_f32 v242, v242, v186
  v_mul_f32 v243, v243, v187
  v_mul_f32 v244, v244, v188
  v_mul_f32 v245, v245, v189
  v_mul_f32 v246, v246, v190
  v_mul_f32 v247, v247, v191
  v_cvt_pk_bf16_f32 v224, v232, v233
  v_cvt_pk_bf16_f32 v225, v234, v235
  v_cvt_pk_bf16_f32 v226, v236, v237
  v_cvt_pk_bf16_f32 v227, v238, v239
  v_cvt_pk_bf16_f32 v228, v240, v241
  v_cvt_pk_bf16_f32 v229, v242, v243
  v_cvt_pk_bf16_f32 v230, v244, v245
  v_cvt_pk_bf16_f32 v231, v246, v247
  s_cmp_eq_u32 s54, 0
  s_cbranch_scc1 K_bskip
  ds_write_b64 v20, v[224:225] offset:0
  ds_write_b64 v20, v[226:227] offset:32
  ds_write_b64 v20, v[228:229] offset:64
  ds_write_b64 v20, v[230:231] offset:96
  s_waitcnt lgkmcnt(0)
  ds_read_b128 v[224:227], v21
  ds_read_b128 v[228:231], v21 offset:1152
  v_add_u32 v2, 9216, v30
  s_waitcnt lgkmcnt(0)
  buffer_store_dwordx4 v[224:227], v30, s[24:27], 0 offen sc1
  buffer_store_dwordx4 v[228:231], v2, s[24:27], 0 offen sc1
K_bskip:
  v_mov_b32 v32, 0
  v_mov_b32 v33, 0
  v_mov_b32 v34, 0
  v_mov_b32 v35, 0
  v_mov_b32 v36, 0
  v_mov_b32 v37, 0
  v_mov_b32 v38, 0
  v_mov_b32 v39, 0
  v_mov_b32 v40, 0
  v_mov_b32 v41, 0
  v_mov_b32 v42, 0
  v_mov_b32 v43, 0
  v_mov_b32 v44, 0
  v_mov_b32 v45, 0
  v_mov_b32 v46, 0
  v_mov_b32 v47, 0
  s_waitcnt vmcnt(0)
  s_barrier
  s_cmp_eq_u32 s54, 0
  s_cbranch_scc1 K_nopostu
  s_lshl_b32 s91, s47, 5
  s_add_u32 s91, s91, s95
  s_cmp_lg_u32 s44, 0
  s_cbranch_scc1 K_post3000
  s_lshl_b32 s52, s91, 2
  s_add_u32 s52, s52, 12288
  v_mov_b32 v2, s52
  v_mov_b32 v3, s51
  s_mov_b64 exec, 1
  buffer_store_dword v3, v2, s[40:43], 0 offen sc1
  s_mov_b64 exec, -1
K_post3000:
K_nopostu:
  buffer_load_dwordx2 v[224:225], v7, s[8:11], 0 offen offset:0
  buffer_load_dwordx2 v[226:227], v7, s[8:11], 0 offen offset:16
  buffer_load_dwordx2 v[228:229], v7, s[8:11], 0 offen offset:32
  buffer_load_dwordx2 v[230:231], v7, s[8:11], 0 offen offset:48
  buffer_load_ushort v9, v9, s[32:35], 0 offen
  s_cmp_lg_u32 s44, 1
  s_cbranch_scc1 K_piU
  v_min_u32 v22, 21, v1
  v_lshlrev_b32 v22, 2, v22
  s_lshl_b32 s52, s47, 7
  s_add_u32 s52, s52, 12288
  v_add_u32 v22, s52, v22
  buffer_load_dword v24, v22, s[40:43], 0 offen sc1
K_piU:
  v_add_u32 v11, 106496, v5
  v_add_u32 v12, 40960, v6
  ds_read_b64_tr_b16 v[96:97], v11 offset:0
  ds_read_b64_tr_b16 v[98:99], v11 offset:512
  ds_read_b64_tr_b16 v[112:113], v12 offset:0
  ds_read_b64_tr_b16 v[114:115], v12 offset:512
  ds_read_b64_tr_b16 v[100:101], v11 offset:2048
  ds_read_b64_tr_b16 v[102:103], v11 offset:2560
  ds_read_b64_tr_b16 v[116:117], v12 offset:2048
  ds_read_b64_tr_b16 v[118:119], v12 offset:2560
  ds_read_b64_tr_b16 v[104:105], v11 offset:4096
  ds_read_b64_tr_b16 v[106:107], v11 offset:4608
  ds_read_b64_tr_b16 v[120:121], v12 offset:4096
  ds_read_b64_tr_b16 v[122:123], v12 offset:4608
  ds_read_b64_tr_b16 v[108:109], v11 offset:6144
  ds_read_b64_tr_b16 v[110:111], v11 offset:6656
  ds_read_b64_tr_b16 v[124:125], v12 offset:6144
  ds_read_b64_tr_b16 v[126:127], v12 offset:6656
  s_barrier
  s_waitcnt lgkmcnt(0)
  v_add_u32 v11, 49152, v5
  v_add_u32 v12, 57344, v6
  v_mfma_f32_32x32x16_bf16 v[32:47], v[96:99], v[112:115], v[32:47]
  ds_read_b64_tr_b16 v[160:161], v11 offset:0
  ds_read_b64_tr_b16 v[162:163], v11 offset:512
  ds_read_b64_tr_b16 v[176:177], v12 offset:0
  ds_read_b64_tr_b16 v[178:179], v12 offset:512
  v_mfma_f32_32x32x16_bf16 v[32:47], v[100:103], v[116:119], v[32:47]
  ds_read_b64_tr_b16 v[164:165], v11 offset:2048
  ds_read_b64_tr_b16 v[166:167], v11 offset:2560
  ds_read_b64_tr_b16 v[180:181], v12 offset:2048
  ds_read_b64_tr_b16 v[182:183], v12 offset:2560
  v_mfma_f32_32x32x16_bf16 v[32:47], v[104:107], v[120:123], v[32:47]
  ds_read_b64_tr_b16 v[168:169], v11 offset:4096
  ds_read_b64_tr_b16 v[170:171], v11 offset:4608
  ds_read_b64_tr_b16 v[184:185], v12 offset:4096
  ds_read_b64_tr_b16 v[186:187], v12 offset:4608
  v_mfma_f32_32x32x16_bf16 v[32:47], v[108:111], v[124:127], v[32:47]
  ds_read_b64_tr_b16 v[172:173], v11 offset:6144
  ds_read_b64_tr_b16 v[174:175], v11 offset:6656
  ds_read_b64_tr_b16 v[188:189], v12 offset:6144
  ds_read_b64_tr_b16 v[190:191], v12 offset:6656
  s_barrier
  s_waitcnt lgkmcnt(0)
  v_add_u32 v11, 114688, v5
  v_add_u32 v12, 16384, v6
  v_mfma_f32_32x32x16_bf16 v[32:47], v[160:163], v[176:179], v[32:47]
  ds_read_b64_tr_b16 v[96:97], v11 offset:0
  ds_read_b64_tr_b16 v[98:99], v11 offset:512
  ds_read_b64_tr_b16 v[112:113], v12 offset:0
  ds_read_b64_tr_b16 v[114:115], v12 offset:512
  v_mfma_f32_32x32x16_bf16 v[32:47], v[164:167], v[180:183], v[32:47]
  ds_read_b64_tr_b16 v[100:101], v11 offset:2048
  ds_read_b64_tr_b16 v[102:103], v11 offset:2560
  ds_read_b64_tr_b16 v[116:117], v12 offset:2048
  ds_read_b64_tr_b16 v[118:119], v12 offset:2560
  v_mfma_f32_32x32x16_bf16 v[32:47], v[168:171], v[184:187], v[32:47]
  ds_read_b64_tr_b16 v[104:105], v11 offset:4096
  ds_read_b64_tr_b16 v[106:107], v11 offset:4608
  ds_read_b64_tr_b16 v[120:121], v12 offset:4096
  ds_read_b64_tr_b16 v[122:123], v12 offset:4608
  v_mfma_f32_32x32x16_bf16 v[32:47], v[172:175], v[188:191], v[32:47]
  ds_read_b64_tr_b16 v[108:109], v11 offset:6144
  ds_read_b64_tr_b16 v[110:111], v11 offset:6656
  ds_read_b64_tr_b16 v[124:125], v12 offset:6144
  ds_read_b64_tr_b16 v[126:127], v12 offset:6656
  s_barrier
  s_waitcnt lgkmcnt(0)
  v_add_u32 v11, 65536, v5
  v_add_u32 v12, 0, v6
  v_mfma_f32_32x32x16_bf16 v[32:47], v[96:99], v[112:115], v[32:47]
  ds_read_b64_tr_b16 v[160:161], v11 offset:0
  ds_read_b64_tr_b16 v[162:163], v11 offset:512
  ds_read_b64_tr_b16 v[176:177], v12 offset:0
  ds_read_b64_tr_b16 v[178:179], v12 offset:512
  v_mfma_f32_32x32x16_bf16 v[32:47], v[100:103], v[116:119], v[32:47]
  ds_read_b64_tr_b16 v[164:165], v11 offset:2048
  ds_read_b64_tr_b16 v[166:167], v11 offset:2560
  ds_read_b64_tr_b16 v[180:181], v12 offset:2048
  ds_read_b64_tr_b16 v[182:183], v12 offset:2560
  v_mfma_f32_32x32x16_bf16 v[32:47], v[104:107], v[120:123], v[32:47]
  ds_read_b64_tr_b16 v[168:169], v11 offset:4096
  ds_read_b64_tr_b16 v[170:171], v11 offset:4608
  ds_read_b64_tr_b16 v[184:185], v12 offset:4096
  ds_read_b64_tr_b16 v[186:187], v12 offset:4608
  v_mfma_f32_32x32x16_bf16 v[32:47], v[108:111], v[124:127], v[32:47]
  ds_read_b64_tr_b16 v[172:173], v11 offset:6144
  ds_read_b64_tr_b16 v[174:175], v11 offset:6656
  ds_read_b64_tr_b16 v[188:189], v12 offset:6144
  ds_read_b64_tr_b16 v[190:191], v12 offset:6656
  s_barrier
  s_waitcnt lgkmcnt(0)
  v_add_u32 v11, 73728, v5
  v_add_u32 v12, 24576, v6
  v_mfma_f32_32x32x16_bf16 v[32:47], v[160:163], v[176:179], v[32:47]
  ds_read_b64_tr_b16 v[96:97], v11 offset:0
  ds_read_b64_tr_b16 v[98:99], v11 offset:512
  ds_read_b64_tr_b16 v[112:113], v12 offset:0
  ds_read_b64_tr_b16 v[114:115], v12 offset:512
  v_mfma_f32_32x32x16_bf16 v[32:47], v[164:167], v[180:183], v[32:47]
  ds_read_b64_tr_b16 v[100:101], v11 offset:2048
  ds_read_b64_tr_b16 v[102:103], v11 offset:2560
  ds_read_b64_tr_b16 v[116:117], v12 offset:2048
  ds_read_b64_tr_b16 v[118:119], v12 offset:2560
  v_mfma_f32_32x32x16_bf16 v[32:47], v[168:171], v[184:187], v[32:47]
  ds_read_b64_tr_b16 v[104:105], v11 offset:4096
  ds_read_b64_tr_b16 v[106:107], v11 offset:4608
  ds_read_b64_tr_b16 v[120:121], v12 offset:4096
  ds_read_b64_tr_b16 v[122:123], v12 offset:4608
  v_mfma_f32_32x32x16_bf16 v[32:47], v[172:175], v[188:191], v[32:47]
  ds_read_b64_tr_b16 v[108:109], v11 offset:6144
  ds_read_b64_tr_b16 v[110:111], v11 offset:6656
  ds_read_b64_tr_b16 v[124:125], v12 offset:6144
  ds_read_b64_tr_b16 v[126:127], v12 offset:6656
  s_cmp_lg_u32 s44, 1
  s_cbranch_scc1 K_pdU
  s_mov_b32 s53, 0
K_plU:
  s_waitcnt vmcnt(0)
  v_cmp_ne_u32 vcc, s51, v24
  s_nop 4
  s_cbranch_vccz K_pdU
  s_add_u32 s53, s53, 1
  s_cmp_lt_u32 s53, 0x80000
  s_cbranch_scc0 K_pdU
  buffer_load_dword v24, v22, s[40:43], 0 offen sc1
  s_branch K_plU
K_pdU:
  s_barrier
  s_waitcnt lgkmcnt(0)
  v_add_u32 v11, 81920, v5
  v_add_u32 v12, 8192, v6
  v_mfma_f32_32x32x16_bf16 v[32:47], v[96:99], v[112:115], v[32:47]
  ds_read_b64_tr_b16 v[160:161], v11 offset:0
  ds_read_b64_tr_b16 v[162:163], v11 offset:512
  ds_read_b64_tr_b16 v[176:177], v12 offset:0
  ds_read_b64_tr_b16 v[178:179], v12 offset:512
  v_mfma_f32_32x32x16_bf16 v[32:47], v[100:103], v[116:119], v[32:47]
  ds_read_b64_tr_b16 v[164:165], v11 offset:2048
  ds_read_b64_tr_b16 v[166:167], v11 offset:2560
  ds_read_b64_tr_b16 v[180:181], v12 offset:2048
  ds_read_b64_tr_b16 v[182:183], v12 offset:2560
  v_mfma_f32_32x32x16_bf16 v[32:47], v[104:107], v[120:123], v[32:47]
  ds_read_b64_tr_b16 v[168:169], v11 offset:4096
  ds_read_b64_tr_b16 v[170:171], v11 offset:4608
  ds_read_b64_tr_b16 v[184:185], v12 offset:4096
  ds_read_b64_tr_b16 v[186:187], v12 offset:4608
  v_mfma_f32_32x32x16_bf16 v[32:47], v[108:111], v[124:127], v[32:47]
  ds_read_b64_tr_b16 v[172:173], v11 offset:6144
  ds_read_b64_tr_b16 v[174:175], v11 offset:6656
  ds_read_b64_tr_b16 v[188:189], v12 offset:6144
  ds_read_b64_tr_b16 v[190:191], v12 offset:6656
  s_barrier
  s_waitcnt lgkmcnt(0)
  v_add_u32 v11, 90112, v5
  v_add_u32 v12, 122880, v6
  v_mfma_f32_32x32x16_bf16 v[32:47], v[160:163], v[176:179], v[32:47]
  ds_read_b64_tr_b16 v[96:97], v11 offset:0
  ds_read_b64_tr_b16 v[98:99], v11 offset:512
  ds_read_b64_tr_b16 v[112:113], v12 offset:0
  ds_read_b64_tr_b16 v[114:115], v12 offset:512
  v_mfma_f32_32x32x16_bf16 v[32:47], v[164:167], v[180:183], v[32:47]
  ds_read_b64_tr_b16 v[100:101], v11 offset:2048
  ds_read_b64_tr_b16 v[102:103], v11 offset:2560
  ds_read_b64_tr_b16 v[116:117], v12 offset:2048
  ds_read_b64_tr_b16 v[118:119], v12 offset:2560
  v_mfma_f32_32x32x16_bf16 v[32:47], v[168:171], v[184:187], v[32:47]
  ds_read_b64_tr_b16 v[104:105], v11 offset:4096
  ds_read_b64_tr_b16 v[106:107], v11 offset:4608
  ds_read_b64_tr_b16 v[120:121], v12 offset:4096
  ds_read_b64_tr_b16 v[122:123], v12 offset:4608
  v_mfma_f32_32x32x16_bf16 v[32:47], v[172:175], v[188:191], v[32:47]
  ds_read_b64_tr_b16 v[108:109], v11 offset:6144
  ds_read_b64_tr_b16 v[110:111], v11 offset:6656
  ds_read_b64_tr_b16 v[124:125], v12 offset:6144
  ds_read_b64_tr_b16 v[126:127], v12 offset:6656
  s_barrier
  s_waitcnt lgkmcnt(0)
  v_add_u32 v11, 131072, v5
  v_add_u32 v12, 32768, v6
  v_mfma_f32_32x32x16_bf16 v[32:47], v[96:99], v[112:115], v[32:47]
  ds_read_b64_tr_b16 v[160:161], v11 offset:0
  ds_read_b64_tr_b16 v[162:163], v11 offset:512
  ds_read_b64_tr_b16 v[176:177], v12 offset:0
  ds_read_b64_tr_b16 v[178:179], v12 offset:512
  v_mfma_f32_32x32x16_bf16 v[32:47], v[100:103], v[116:119], v[32:47]
  ds_read_b64_tr_b16 v[164:165], v11 offset:2048
  ds_read_b64_tr_b16 v[166:167], v11 offset:2560
  ds_read_b64_tr_b16 v[180:181], v12 offset:2048
  ds_read_b64_tr_b16 v[182:183], v12 offset:2560
  v_mfma_f32_32x32x16_bf16 v[32:47], v[104:107], v[120:123], v[32:47]
  ds_read_b64_tr_b16 v[168:169], v11 offset:4096
  ds_read_b64_tr_b16 v[170:171], v11 offset:4608
  ds_read_b64_tr_b16 v[184:185], v12 offset:4096
  ds_read_b64_tr_b16 v[186:187], v12 offset:4608
  v_mfma_f32_32x32x16_bf16 v[32:47], v[108:111], v[124:127], v[32:47]
  ds_read_b64_tr_b16 v[172:173], v11 offset:6144
  ds_read_b64_tr_b16 v[174:175], v11 offset:6656
  ds_read_b64_tr_b16 v[188:189], v12 offset:6144
  ds_read_b64_tr_b16 v[190:191], v12 offset:6656
  s_barrier
  s_waitcnt lgkmcnt(0)
  v_add_u32 v11, 0, v5
  v_add_u32 v12, 98304, v6
  v_mfma_f32_32x32x16_bf16 v[32:47], v[160:163], v[176:179], v[32:47]
  ds_read_b64_tr_b16 v[96:97], v11 offset:0
  ds_read_b64_tr_b16 v[98:99], v11 offset:512
  ds_read_b64_tr_b16 v[112:113], v12 offset:0
  ds_read_b64_tr_b16 v[114:115], v12 offset:512
  v_mfma_f32_32x32x16_bf16 v[32:47], v[164:167], v[180:183], v[32:47]
  ds_read_b64_tr_b16 v[100:101], v11 offset:2048
  ds_read_b64_tr_b16 v[102:103], v11 offset:2560
  ds_read_b64_tr_b16 v[116:117], v12 offset:2048
  ds_read_b64_tr_b16 v[118:119], v12 offset:2560
  v_mfma_f32_32x32x16_bf16 v[32:47], v[168:171], v[184:187], v[32:47]
  ds_read_b64_tr_b16 v[104:105], v11 offset:4096
  ds_read_b64_tr_b16 v[106:107], v11 offset:4608
  ds_read_b64_tr_b16 v[120:121], v12 offset:4096
  ds_read_b64_tr_b16 v[122:123], v12 offset:4608
  v_mfma_f32_32x32x16_bf16 v[32:47], v[172:175], v[188:191], v[32:47]
  ds_read_b64_tr_b16 v[108:109], v11 offset:6144
  ds_read_b64_tr_b16 v[110:111], v11 offset:6656
  ds_read_b64_tr_b16 v[124:125], v12 offset:6144
  ds_read_b64_tr_b16 v[126:127], v12 offset:6656
  s_barrier
  s_waitcnt lgkmcnt(0)
  v_add_u32 v11, 65536, v5
  v_add_u32 v12, 139264, v6
  v_mfma_f32_32x32x16_bf16 v[32:47], v[96:99], v[112:115], v[32:47]
  ds_read_b64_tr_b16 v[160:161], v11 offset:0
  ds_read_b64_tr_b16 v[162:163], v11 offset:512
  ds_read_b64_tr_b16 v[176:177], v12 offset:0
  ds_read_b64_tr_b16 v[178:179], v12 offset:512
  v_mfma_f32_32x32x16_bf16 v[32:47], v[100:103], v[116:119], v[32:47]
  ds_read_b64_tr_b16 v[164:165], v11 offset:2048
  ds_read_b64_tr_b16 v[166:167], v11 offset:2560
  ds_read_b64_tr_b16 v[180:181], v12 offset:2048
  ds_read_b64_tr_b16 v[182:183], v12 offset:2560
  v_mfma_f32_32x32x16_bf16 v[32:47], v[104:107], v[120:123], v[32:47]
  ds_read_b64_tr_b16 v[168:169], v11 offset:4096
  ds_read_b64_tr_b16 v[170:171], v11 offset:4608
  ds_read_b64_tr_b16 v[184:185], v12 offset:4096
  ds_read_b64_tr_b16 v[186:187], v12 offset:4608
  v_mfma_f32_32x32x16_bf16 v[32:47], v[108:111], v[124:127], v[32:47]
  ds_read_b64_tr_b16 v[172:173], v11 offset:6144
  ds_read_b64_tr_b16 v[174:175], v11 offset:6656
  ds_read_b64_tr_b16 v[188:189], v12 offset:6144
  ds_read_b64_tr_b16 v[190:191], v12 offset:6656
  s_barrier
  s_waitcnt lgkmcnt(0)
  v_add_u32 v11, 24576, v5
  v_add_u32 v12, 40960, v6
  v_mfma_f32_32x32x16_bf16 v[32:47], v[160:163], v[176:179], v[32:47]
  ds_read_b64_tr_b16 v[96:97], v11 offset:0
  ds_read_b64_tr_b16 v[98:99], v11 offset:512
  ds_read_b64_tr_b16 v[112:113], v12 offset:0
  ds_read_b64_tr_b16 v[114:115], v12 offset:512
  v_mfma_f32_32x32x16_bf16 v[32:47], v[164:167], v[180:183], v[32:47]
  ds_read_b64_tr_b16 v[100:101], v11 offset:2048
  ds_read_b64_tr_b16 v[102:103], v11 offset:2560
  ds_read_b64_tr_b16 v[116:117], v12 offset:2048
  ds_read_b64_tr_b16 v[118:119], v12 offset:2560
  v_mfma_f32_32x32x16_bf16 v[32:47], v[168:171], v[184:187], v[32:47]
  ds_read_b64_tr_b16 v[104:105], v11 offset:4096
  ds_read_b64_tr_b16 v[106:107], v11 offset:4608
  ds_read_b64_tr_b16 v[120:121], v12 offset:4096
  ds_read_b64_tr_b16 v[122:123], v12 offset:4608
  v_mfma_f32_32x32x16_bf16 v[32:47], v[172:175], v[188:191], v[32:47]
  ds_read_b64_tr_b16 v[108:109], v11 offset:6144
  ds_read_b64_tr_b16 v[110:111], v11 offset:6656
  ds_read_b64_tr_b16 v[124:125], v12 offset:6144
  ds_read_b64_tr_b16 v[126:127], v12 offset:6656
  s_barrier
  s_waitcnt lgkmcnt(0)
  v_add_u32 v11, 73728, v5
  v_add_u32 v12, 106496, v6
  v_mfma_f32_32x32x16_bf16 v[32:47], v[96:99], v[112:115], v[32:47]
  ds_read_b64_tr_b16 v[160:161], v11 offset:0
  ds_read_b64_tr_b16 v[162:163], v11 offset:512
  ds_read_b64_tr_b16 v[176:177], v12 offset:0
  ds_read_b64_tr_b16 v[178:179], v12 offset:512
  v_mfma_f32_32x32x16_bf16 v[32:47], v[100:103], v[116:119], v[32:47]
  ds_read_b64_tr_b16 v[164:165], v11 offset:2048
  ds_read_b64_tr_b16 v[166:167], v11 offset:2560
  ds_read_b64_tr_b16 v[180:181], v12 offset:2048
  ds_read_b64_tr_b16 v[182:183], v12 offset:2560
  v_mfma_f32_32x32x16_bf16 v[32:47], v[104:107], v[120:123], v[32:47]
  ds_read_b64_tr_b16 v[168:169], v11 offset:4096
  ds_read_b64_tr_b16 v[170:171], v11 offset:4608
  ds_read_b64_tr_b16 v[184:185], v12 offset:4096
  ds_read_b64_tr_b16 v[186:187], v12 offset:4608
  v_mfma_f32_32x32x16_bf16 v[32:47], v[108:111], v[124:127], v[32:47]
  ds_read_b64_tr_b16 v[172:173], v11 offset:6144
  ds_read_b64_tr_b16 v[174:175], v11 offset:6656
  ds_read_b64_tr_b16 v[188:189], v12 offset:6144
  ds_read_b64_tr_b16 v[190:191], v12 offset:6656
  s_barrier
  s_waitcnt lgkmcnt(0)
  v_add_u32 v11, 8192, v5
  v_add_u32 v12, 49152, v6
  v_mfma_f32_32x32x16_bf16 v[32:47], v[160:163], v[176:179], v[32:47]
  ds_read_b64_tr_b16 v[96:97], v11 offset:0
  ds_read_b64_tr_b16 v[98:99], v11 offset:512
  ds_read_b64_tr_b16 v[112:113], v12 offset:0
  ds_read_b64_tr_b16 v[114:115], v12 offset:512
  v_mfma_f32_32x32x16_bf16 v[32:47], v[164:167], v[180:183], v[32:47]
  ds_read_b64_tr_b16 v[100:101], v11 offset:2048
  ds_read_b64_tr_b16 v[102:103], v11 offset:2560
  ds_read_b64_tr_b16 v[116:117], v12 offset:2048
  ds_read_b64_tr_b16 v[118:119], v12 offset:2560
  v_mfma_f32_32x32x16_bf16 v[32:47], v[168:171], v[184:187], v[32:47]
  ds_read_b64_tr_b16 v[104:105], v11 offset:4096
  ds_read_b64_tr_b16 v[106:107], v11 offset:4608
  ds_read_b64_tr_b16 v[120:121], v12 offset:4096
  ds_read_b64_tr_b16 v[122:123], v12 offset:4608
  v_mfma_f32_32x32x16_bf16 v[32:47], v[172:175], v[188:191], v[32:47]
  ds_read_b64_tr_b16 v[108:109], v11 offset:6144
  ds_read_b64_tr_b16 v[110:111], v11 offset:6656
  ds_read_b64_tr_b16 v[124:125], v12 offset:6144
  ds_read_b64_tr_b16 v[126:127], v12 offset:6656
  s_barrier
  s_waitcnt lgkmcnt(0)
  v_add_u32 v11, 81920, v5
  v_add_u32 v12, 57344, v6
  v_mfma_f32_32x32x16_bf16 v[32:47], v[96:99], v[112:115], v[32:47]
  ds_read_b64_tr_b16 v[160:161], v11 offset:0
  ds_read_b64_tr_b16 v[162:163], v11 offset:512
  ds_read_b64_tr_b16 v[176:177], v12 offset:0
  ds_read_b64_tr_b16 v[178:179], v12 offset:512
  v_mfma_f32_32x32x16_bf16 v[32:47], v[100:103], v[116:119], v[32:47]
  ds_read_b64_tr_b16 v[164:165], v11 offset:2048
  ds_read_b64_tr_b16 v[166:167], v11 offset:2560
  ds_read_b64_tr_b16 v[180:181], v12 offset:2048
  ds_read_b64_tr_b16 v[182:183], v12 offset:2560
  v_mfma_f32_32x32x16_bf16 v[32:47], v[104:107], v[120:123], v[32:47]
  ds_read_b64_tr_b16 v[168:169], v11 offset:4096
  ds_read_b64_tr_b16 v[170:171], v11 offset:4608
  ds_read_b64_tr_b16 v[184:185], v12 offset:4096
  ds_read_b64_tr_b16 v[186:187], v12 offset:4608
  v_mfma_f32_32x32x16_bf16 v[32:47], v[108:111], v[124:127], v[32:47]
  ds_read_b64_tr_b16 v[172:173], v11 offset:6144
  ds_read_b64_tr_b16 v[174:175], v11 offset:6656
  ds_read_b64_tr_b16 v[188:189], v12 offset:6144
  ds_read_b64_tr_b16 v[190:191], v12 offset:6656
  s_barrier
  s_waitcnt lgkmcnt(0)
  v_add_u32 v11, 90112, v5
  v_add_u32 v12, 16384, v6
  v_mfma_f32_32x32x16_bf16 v[32:47], v[160:163], v[176:179], v[32:47]
  ds_read_b64_tr_b16 v[96:97], v11 offset:0
  ds_read_b64_tr_b16 v[98:99], v11 offset:512
  ds_read_b64_tr_b16 v[112:113], v12 offset:0
  ds_read_b64_tr_b16 v[114:115], v12 offset:512
  v_mfma_f32_32x32x16_bf16 v[32:47], v[164:167], v[180:183], v[32:47]
  ds_read_b64_tr_b16 v[100:101], v11 offset:2048
  ds_read_b64_tr_b16 v[102:103], v11 offset:2560
  ds_read_b64_tr_b16 v[116:117], v12 offset:2048
  ds_read_b64_tr_b16 v[118:119], v12 offset:2560
  v_mfma_f32_32x32x16_bf16 v[32:47], v[168:171], v[184:187], v[32:47]
  ds_read_b64_tr_b16 v[104:105], v11 offset:4096
  ds_read_b64_tr_b16 v[106:107], v11 offset:4608
  ds_read_b64_tr_b16 v[120:121], v12 offset:4096
  ds_read_b64_tr_b16 v[122:123], v12 offset:4608
  v_mfma_f32_32x32x16_bf16 v[32:47], v[172:175], v[188:191], v[32:47]
  ds_read_b64_tr_b16 v[108:109], v11 offset:6144
  ds_read_b64_tr_b16 v[110:111], v11 offset:6656
  ds_read_b64_tr_b16 v[124:125], v12 offset:6144
  ds_read_b64_tr_b16 v[126:127], v12 offset:6656
  s_barrier
  s_waitcnt lgkmcnt(0)
  v_add_u32 v11, 122880, v5
  v_add_u32 v12, 114688, v6
  v_mfma_f32_32x32x16_bf16 v[32:47], v[96:99], v[112:115], v[32:47]
  ds_read_b64_tr_b16 v[160:161], v11 offset:0
  ds_read_b64_tr_b16 v[162:163], v11 offset:512
  ds_read_b64_tr_b16 v[176:177], v12 offset:0
  ds_read_b64_tr_b16 v[178:179], v12 offset:512
  v_mfma_f32_32x32x16_bf16 v[32:47], v[100:103], v[116:119], v[32:47]
  ds_read_b64_tr_b16 v[164:165], v11 offset:2048
  ds_read_b64_tr_b16 v[166:167], v11 offset:2560
  ds_read_b64_tr_b16 v[180:181], v12 offset:2048
  ds_read_b64_tr_b16 v[182:183], v12 offset:2560
  v_mfma_f32_32x32x16_bf16 v[32:47], v[104:107], v[120:123], v[32:47]
  ds_read_b64_tr_b16 v[168:169], v11 offset:4096
  ds_read_b64_tr_b16 v[170:171], v11 offset:4608
  ds_read_b64_tr_b16 v[184:185], v12 offset:4096
  ds_read_b64_tr_b16 v[186:187], v12 offset:4608
  v_mfma_f32_32x32x16_bf16 v[32:47], v[108:111], v[124:127], v[32:47]
  ds_read_b64_tr_b16 v[172:173], v11 offset:6144
  ds_read_b64_tr_b16 v[174:175], v11 offset:6656
  ds_read_b64_tr_b16 v[188:189], v12 offset:6144
  ds_read_b64_tr_b16 v[190:191], v12 offset:6656
  s_barrier
  s_waitcnt lgkmcnt(0)
  v_add_u32 v11, 32768, v5
  v_add_u32 v12, 131072, v6
  v_mfma_f32_32x32x16_bf16 v[32:47], v[160:163], v[176:179], v[32:47]
  ds_read_b64_tr_b16 v[96:97], v11 offset:0
  ds_read_b64_tr_b16 v[98:99], v11 offset:512
  ds_read_b64_tr_b16 v[112:113], v12 offset:0
  ds_read_b64_tr_b16 v[114:115], v12 offset:512
  v_mfma_f32_32x32x16_bf16 v[32:47], v[164:167], v[180:183], v[32:47]
  ds_read_b64_tr_b16 v[100:101], v11 offset:2048
  ds_read_b64_tr_b16 v[102:103], v11 offset:2560
  ds_read_b64_tr_b16 v[116:117], v12 offset:2048
  ds_read_b64_tr_b16 v[118:119], v12 offset:2560
  v_mfma_f32_32x32x16_bf16 v[32:47], v[168:171], v[184:187], v[32:47]
  ds_read_b64_tr_b16 v[104:105], v11 offset:4096
  ds_read_b64_tr_b16 v[106:107], v11 offset:4608
  ds_read_b64_tr_b16 v[120:121], v12 offset:4096
  ds_read_b64_tr_b16 v[122:123], v12 offset:4608
  v_mfma_f32_32x32x16_bf16 v[32:47], v[172:175], v[188:191], v[32:47]
  ds_read_b64_tr_b16 v[108:109], v11 offset:6144
  ds_read_b64_tr_b16 v[110:111], v11 offset:6656
  ds_read_b64_tr_b16 v[124:125], v12 offset:6144
  ds_read_b64_tr_b16 v[126:127], v12 offset:6656
  s_barrier
  s_waitcnt lgkmcnt(0)
  v_add_u32 v11, 0, v5
  v_add_u32 v12, 98304, v6
  v_mfma_f32_32x32x16_bf16 v[32:47], v[96:99], v[112:115], v[32:47]
  ds_read_b64_tr_b16 v[160:161], v11 offset:0
  ds_read_b64_tr_b16 v[162:163], v11 offset:512
  ds_read_b64_tr_b16 v[176:177], v12 offset:0
  ds_read_b64_tr_b16 v[178:179], v12 offset:512
  v_mfma_f32_32x32x16_bf16 v[32:47], v[100:103], v[116:119], v[32:47]
  ds_read_b64_tr_b16 v[164:165], v11 offset:2048
  ds_read_b64_tr_b16 v[166:167], v11 offset:2560
  ds_read_b64_tr_b16 v[180:181], v12 offset:2048
  ds_read_b64_tr_b16 v[182:183], v12 offset:2560
  v_mfma_f32_32x32x16_bf16 v[32:47], v[104:107], v[120:123], v[32:47]
  ds_read_b64_tr_b16 v[168:169], v11 offset:4096
  ds_read_b64_tr_b16 v[170:171], v11 offset:4608
  ds_read_b64_tr_b16 v[184:185], v12 offset:4096
  ds_read_b64_tr_b16 v[186:187], v12 offset:4608
  v_mfma_f32_32x32x16_bf16 v[32:47], v[108:111], v[124:127], v[32:47]
  ds_read_b64_tr_b16 v[172:173], v11 offset:6144
  ds_read_b64_tr_b16 v[174:175], v11 offset:6656
  ds_read_b64_tr_b16 v[188:189], v12 offset:6144
  ds_read_b64_tr_b16 v[190:191], v12 offset:6656
  s_barrier
  s_waitcnt lgkmcnt(0)
  v_add_u32 v11, 65536, v5
  v_add_u32 v12, 139264, v6
  v_mfma_f32_32x32x16_bf16 v[32:47], v[160:163], v[176:179], v[32:47]
  ds_read_b64_tr_b16 v[96:97], v11 offset:0
  ds_read_b64_tr_b16 v[98:99], v11 offset:512
  ds_read_b64_tr_b16 v[112:113], v12 offset:0
  ds_read_b64_tr_b16 v[114:115], v12 offset:512
  v_mfma_f32_32x32x16_bf16 v[32:47], v[164:167], v[180:183], v[32:47]
  ds_read_b64_tr_b16 v[100:101], v11 offset:2048
  ds_read_b64_tr_b16 v[102:103], v11 offset:2560
  ds_read_b64_tr_b16 v[116:117], v12 offset:2048
  ds_read_b64_tr_b16 v[118:119], v12 offset:2560
  v_mfma_f32_32x32x16_bf16 v[32:47], v[168:171], v[184:187], v[32:47]
  ds_read_b64_tr_b16 v[104:105], v11 offset:4096
  ds_read_b64_tr_b16 v[106:107], v11 offset:4608
  ds_read_b64_tr_b16 v[120:121], v12 offset:4096
  ds_read_b64_tr_b16 v[122:123], v12 offset:4608
  v_mfma_f32_32x32x16_bf16 v[32:47], v[172:175], v[188:191], v[32:47]
  ds_read_b64_tr_b16 v[108:109], v11 offset:6144
  ds_read_b64_tr_b16 v[110:111], v11 offset:6656
  ds_read_b64_tr_b16 v[124:125], v12 offset:6144
  ds_read_b64_tr_b16 v[126:127], v12 offset:6656
  s_barrier
  s_waitcnt lgkmcnt(0)
  v_add_u32 v11, 24576, v5
  v_add_u32 v12, 40960, v6
  v_mfma_f32_32x32x16_bf16 v[32:47], v[96:99], v[112:115], v[32:47]
  ds_read_b64_tr_b16 v[160:161], v11 offset:0
  ds_read_b64_tr_b16 v[162:163], v11 offset:512
  ds_read_b64_tr_b16 v[176:177], v12 offset:0
  ds_read_b64_tr_b16 v[178:179], v12 offset:512
  v_mfma_f32_32x32x16_bf16 v[32:47], v[100:103], v[116:119], v[32:47]
  ds_read_b64_tr_b16 v[164:165], v11 offset:2048
  ds_read_b64_tr_b16 v[166:167], v11 offset:2560
  ds_read_b64_tr_b16 v[180:181], v12 offset:2048
  ds_read_b64_tr_b16 v[182:183], v12 offset:2560
  v_mfma_f32_32x32x16_bf16 v[32:47], v[104:107], v[120:123], v[32:47]
  ds_read_b64_tr_b16 v[168:169], v11 offset:4096
  ds_read_b64_tr_b16 v[170:171], v11 offset:4608
  ds_read_b64_tr_b16 v[184:185], v12 offset:4096
  ds_read_b64_tr_b16 v[186:187], v12 offset:4608
  v_mfma_f32_32x32x16_bf16 v[32:47], v[108:111], v[124:127], v[32:47]
  ds_read_b64_tr_b16 v[172:173], v11 offset:6144
  ds_read_b64_tr_b16 v[174:175], v11 offset:6656
  ds_read_b64_tr_b16 v[188:189], v12 offset:6144
  ds_read_b64_tr_b16 v[190:191], v12 offset:6656
  s_barrier
  s_waitcnt lgkmcnt(0)
  v_add_u32 v11, 73728, v5
  v_add_u32 v12, 106496, v6
  v_mfma_f32_32x32x16_bf16 v[32:47], v[160:163], v[176:179], v[32:47]
  ds_read_b64_tr_b16 v[96:97], v11 offset:0
  ds_read_b64_tr_b16 v[98:99], v11 offset:512
  ds_read_b64_tr_b16 v[112:113], v12 offset:0
  ds_read_b64_tr_b16 v[114:115], v12 offset:512
  v_mfma_f32_32x32x16_bf16 v[32:47], v[164:167], v[180:183], v[32:47]
  ds_read_b64_tr_b16 v[100:101], v11 offset:2048
  ds_read_b64_tr_b16 v[102:103], v11 offset:2560
  ds_read_b64_tr_b16 v[116:117], v12 offset:2048
  ds_read_b64_tr_b16 v[118:119], v12 offset:2560
  v_mfma_f32_32x32x16_bf16 v[32:47], v[168:171], v[184:187], v[32:47]
  ds_read_b64_tr_b16 v[104:105], v11 offset:4096
  ds_read_b64_tr_b16 v[106:107], v11 offset:4608
  ds_read_b64_tr_b16 v[120:121], v12 offset:4096
  ds_read_b64_tr_b16 v[122:123], v12 offset:4608
  v_mfma_f32_32x32x16_bf16 v[32:47], v[172:175], v[188:191], v[32:47]
  ds_read_b64_tr_b16 v[108:109], v11 offset:6144
  ds_read_b64_tr_b16 v[110:111], v11 offset:6656
  ds_read_b64_tr_b16 v[124:125], v12 offset:6144
  ds_read_b64_tr_b16 v[126:127], v12 offset:6656
  s_barrier
  s_waitcnt lgkmcnt(0)
  v_add_u32 v11, 8192, v5
  v_add_u32 v12, 49152, v6
  v_mfma_f32_32x32x16_bf16 v[32:47], v[96:99], v[112:115], v[32:47]
  ds_read_b64_tr_b16 v[160:161], v11 offset:0
  ds_read_b64_tr_b16 v[162:163], v11 offset:512
  ds_read_b64_tr_b16 v[176:177], v12 offset:0
  ds_read_b64_tr_b16 v[178:179], v12 offset:512
  v_mfma_f32_32x32x16_bf16 v[32:47], v[100:103], v[116:119], v[32:47]
  ds_read_b64_tr_b16 v[164:165], v11 offset:2048
  ds_read_b64_tr_b16 v[166:167], v11 offset:2560
  ds_read_b64_tr_b16 v[180:181], v12 offset:2048
  ds_read_b64_tr_b16 v[182:183], v12 offset:2560
  v_mfma_f32_32x32x16_bf16 v[32:47], v[104:107], v[120:123], v[32:47]
  ds_read_b64_tr_b16 v[168:169], v11 offset:4096
  ds_read_b64_tr_b16 v[170:171], v11 offset:4608
  ds_read_b64_tr_b16 v[184:185], v12 offset:4096
  ds_read_b64_tr_b16 v[186:187], v12 offset:4608
  v_mfma_f32_32x32x16_bf16 v[32:47], v[108:111], v[124:127], v[32:47]
  ds_read_b64_tr_b16 v[172:173], v11 offset:6144
  ds_read_b64_tr_b16 v[174:175], v11 offset:6656
  ds_read_b64_tr_b16 v[188:189], v12 offset:6144
  ds_read_b64_tr_b16 v[190:191], v12 offset:6656
  s_barrier
  s_waitcnt lgkmcnt(0)
  v_add_u32 v11, 57344, v5
  v_add_u32 v12, 81920, v6
  v_mfma_f32_32x32x16_bf16 v[32:47], v[160:163], v[176:179], v[32:47]
  ds_read_b64_tr_b16 v[96:97], v11 offset:0
  ds_read_b64_tr_b16 v[98:99], v11 offset:512
  ds_read_b64_tr_b16 v[112:113], v12 offset:0
  ds_read_b64_tr_b16 v[114:115], v12 offset:512
  v_mfma_f32_32x32x16_bf16 v[32:47], v[164:167], v[180:183], v[32:47]
  ds_read_b64_tr_b16 v[100:101], v11 offset:2048
  ds_read_b64_tr_b16 v[102:103], v11 offset:2560
  ds_read_b64_tr_b16 v[116:117], v12 offset:2048
  ds_read_b64_tr_b16 v[118:119], v12 offset:2560
  v_mfma_f32_32x32x16_bf16 v[32:47], v[168:171], v[184:187], v[32:47]
  ds_read_b64_tr_b16 v[104:105], v11 offset:4096
  ds_read_b64_tr_b16 v[106:107], v11 offset:4608
  ds_read_b64_tr_b16 v[120:121], v12 offset:4096
  ds_read_b64_tr_b16 v[122:123], v12 offset:4608
  v_mfma_f32_32x32x16_bf16 v[32:47], v[172:175], v[188:191], v[32:47]
  ds_read_b64_tr_b16 v[108:109], v11 offset:6144
  ds_read_b64_tr_b16 v[110:111], v11 offset:6656
  ds_read_b64_tr_b16 v[124:125], v12 offset:6144
  ds_read_b64_tr_b16 v[126:127], v12 offset:6656
  s_barrier
  s_waitcnt lgkmcnt(0)
  v_add_u32 v11, 16384, v5
  v_add_u32 v12, 90112, v6
  v_mfma_f32_32x32x16_bf16 v[32:47], v[96:99], v[112:115], v[32:47]
  ds_read_b64_tr_b16 v[160:161], v11 offset:0
  ds_read_b64_tr_b16 v[162:163], v11 offset:512
  ds_read_b64_tr_b16 v[176:177], v12 offset:0
  ds_read_b64_tr_b16 v[178:179], v12 offset:512
  v_mfma_f32_32x32x16_bf16 v[32:47], v[100:103], v[116:119], v[32:47]
  ds_read_b64_tr_b16 v[164:165], v11 offset:2048
  ds_read_b64_tr_b16 v[166:167], v11 offset:2560
  ds_read_b64_tr_b16 v[180:181], v12 offset:2048
  ds_read_b64_tr_b16 v[182:183], v12 offset:2560
  v_mfma_f32_32x32x16_bf16 v[32:47], v[104:107], v[120:123], v[32:47]
  ds_read_b64_tr_b16 v[168:169], v11 offset:4096
  ds_read_b64_tr_b16 v[170:171], v11 offset:4608
  ds_read_b64_tr_b16 v[184:185], v12 offset:4096
  ds_read_b64_tr_b16 v[186:187], v12 offset:4608
  v_mfma_f32_32x32x16_bf16 v[32:47], v[108:111], v[124:127], v[32:47]
  ds_read_b64_tr_b16 v[172:173], v11 offset:6144
  ds_read_b64_tr_b16 v[174:175], v11 offset:6656
  ds_read_b64_tr_b16 v[188:189], v12 offset:6144
  ds_read_b64_tr_b16 v[190:191], v12 offset:6656
  s_barrier
  s_waitcnt lgkmcnt(0)
  v_add_u32 v11, 114688, v5
  v_add_u32 v12, 122880, v6
  v_mfma_f32_32x32x16_bf16 v[32:47], v[160:163], v[176:179], v[32:47]
  ds_read_b64_tr_b16 v[96:97], v11 offset:0
  ds_read_b64_tr_b16 v[98:99], v11 offset:512
  ds_read_b64_tr_b16 v[112:113], v12 offset:0
  ds_read_b64_tr_b16 v[114:115], v12 offset:512
  v_mfma_f32_32x32x16_bf16 v[32:47], v[164:167], v[180:183], v[32:47]
  ds_read_b64_tr_b16 v[100:101], v11 offset:2048
  ds_read_b64_tr_b16 v[102:103], v11 offset:2560
  ds_read_b64_tr_b16 v[116:117], v12 offset:2048
  ds_read_b64_tr_b16 v[118:119], v12 offset:2560
  v_mfma_f32_32x32x16_bf16 v[32:47], v[168:171], v[184:187], v[32:47]
  ds_read_b64_tr_b16 v[104:105], v11 offset:4096
  ds_read_b64_tr_b16 v[106:107], v11 offset:4608
  ds_read_b64_tr_b16 v[120:121], v12 offset:4096
  ds_read_b64_tr_b16 v[122:123], v12 offset:4608
  v_mfma_f32_32x32x16_bf16 v[32:47], v[172:175], v[188:191], v[32:47]
  ds_read_b64_tr_b16 v[108:109], v11 offset:6144
  ds_read_b64_tr_b16 v[110:111], v11 offset:6656
  ds_read_b64_tr_b16 v[124:125], v12 offset:6144
  ds_read_b64_tr_b16 v[126:127], v12 offset:6656
  s_barrier
  s_waitcnt lgkmcnt(0)
  v_add_u32 v11, 32768, v5
  v_add_u32 v12, 131072, v6
  v_mfma_f32_32x32x16_bf16 v[32:47], v[96:99], v[112:115], v[32:47]
  ds_read_b64_tr_b16 v[160:161], v11 offset:0
  ds_read_b64_tr_b16 v[162:163], v11 offset:512
  ds_read_b64_tr_b16 v[176:177], v12 offset:0
  ds_read_b64_tr_b16 v[178:179], v12 offset:512
  v_mfma_f32_32x32x16_bf16 v[32:47], v[100:103], v[116:119], v[32:47]
  ds_read_b64_tr_b16 v[164:165], v11 offset:2048
  ds_read_b64_tr_b16 v[166:167], v11 offset:2560
  ds_read_b64_tr_b16 v[180:181], v12 offset:2048
  ds_read_b64_tr_b16 v[182:183], v12 offset:2560
  v_mfma_f32_32x32x16_bf16 v[32:47], v[104:107], v[120:123], v[32:47]
  ds_read_b64_tr_b16 v[168:169], v11 offset:4096
  ds_read_b64_tr_b16 v[170:171], v11 offset:4608
  ds_read_b64_tr_b16 v[184:185], v12 offset:4096
  ds_read_b64_tr_b16 v[186:187], v12 offset:4608
  v_mfma_f32_32x32x16_bf16 v[32:47], v[108:111], v[124:127], v[32:47]
  ds_read_b64_tr_b16 v[172:173], v11 offset:6144
  ds_read_b64_tr_b16 v[174:175], v11 offset:6656
  ds_read_b64_tr_b16 v[188:189], v12 offset:6144
  ds_read_b64_tr_b16 v[190:191], v12 offset:6656
  s_barrier
  s_waitcnt lgkmcnt(0)
  v_add_u32 v11, 0, v5
  v_add_u32 v12, 98304, v6
  v_mfma_f32_32x32x16_bf16 v[32:47], v[160:163], v[176:179], v[32:47]
  ds_read_b64_tr_b16 v[96:97], v11 offset:0
  ds_read_b64_tr_b16 v[98:99], v11 offset:512
  ds_read_b64_tr_b16 v[112:113], v12 offset:0
  ds_read_b64_tr_b16 v[114:115], v12 offset:512
  v_mfma_f32_32x32x16_bf16 v[32:47], v[164:167], v[180:183], v[32:47]
  ds_read_b64_tr_b16 v[100:101], v11 offset:2048
  ds_read_b64_tr_b16 v[102:103], v11 offset:2560
  ds_read_b64_tr_b16 v[116:117], v12 offset:2048
  ds_read_b64_tr_b16 v[118:119], v12 offset:2560
  v_mfma_f32_32x32x16_bf16 v[32:47], v[168:171], v[184:187], v[32:47]
  ds_read_b64_tr_b16 v[104:105], v11 offset:4096
  ds_read_b64_tr_b16 v[106:107], v11 offset:4608
  ds_read_b64_tr_b16 v[120:121], v12 offset:4096
  ds_read_b64_tr_b16 v[122:123], v12 offset:4608
  v_mfma_f32_32x32x16_bf16 v[32:47], v[172:175], v[188:191], v[32:47]
  ds_read_b64_tr_b16 v[108:109], v11 offset:6144
  ds_read_b64_tr_b16 v[110:111], v11 offset:6656
  ds_read_b64_tr_b16 v[124:125], v12 offset:6144
  ds_read_b64_tr_b16 v[126:127], v12 offset:6656
  s_barrier
  s_waitcnt lgkmcnt(0)
  v_add_u32 v11, 65536, v5
  v_add_u32 v12, 139264, v6
  v_mfma_f32_32x32x16_bf16 v[32:47], v[96:99], v[112:115], v[32:47]
  ds_read_b64_tr_b16 v[160:161], v11 offset:0
  ds_read_b64_tr_b16 v[162:163], v11 offset:512
  ds_read_b64_tr_b16 v[176:177], v12 offset:0
  ds_read_b64_tr_b16 v[178:179], v12 offset:512
  v_mfma_f32_32x32x16_bf16 v[32:47], v[100:103], v[116:119], v[32:47]
  ds_read_b64_tr_b16 v[164:165], v11 offset:2048
  ds_read_b64_tr_b16 v[166:167], v11 offset:2560
  ds_read_b64_tr_b16 v[180:181], v12 offset:2048
  ds_read_b64_tr_b16 v[182:183], v12 offset:2560
  v_mfma_f32_32x32x16_bf16 v[32:47], v[104:107], v[120:123], v[32:47]
  ds_read_b64_tr_b16 v[168:169], v11 offset:4096
  ds_read_b64_tr_b16 v[170:171], v11 offset:4608
  ds_read_b64_tr_b16 v[184:185], v12 offset:4096
  ds_read_b64_tr_b16 v[186:187], v12 offset:4608
  v_mfma_f32_32x32x16_bf16 v[32:47], v[108:111], v[124:127], v[32:47]
  ds_read_b64_tr_b16 v[172:173], v11 offset:6144
  ds_read_b64_tr_b16 v[174:175], v11 offset:6656
  ds_read_b64_tr_b16 v[188:189], v12 offset:6144
  ds_read_b64_tr_b16 v[190:191], v12 offset:6656
  s_barrier
  s_waitcnt lgkmcnt(0)
  v_add_u32 v11, 24576, v5
  v_add_u32 v12, 40960, v6
  v_mfma_f32_32x32x16_bf16 v[32:47], v[160:163], v[176:179], v[32:47]
  ds_read_b64_tr_b16 v[96:97], v11 offset:0
  ds_read_b64_tr_b16 v[98:99], v11 offset:512
  ds_read_b64_tr_b16 v[112:113], v12 offset:0
  ds_read_b64_tr_b16 v[114:115], v12 offset:512
  v_mfma_f32_32x32x16_bf16 v[32:47], v[164:167], v[180:183], v[32:47]
  ds_read_b64_tr_b16 v[100:101], v11 offset:2048
  ds_read_b64_tr_b16 v[102:103], v11 offset:2560
  ds_read_b64_tr_b16 v[116:117], v12 offset:2048
  ds_read_b64_tr_b16 v[118:119], v12 offset:2560
  v_mfma_f32_32x32x16_bf16 v[32:47], v[168:171], v[184:187], v[32:47]
  ds_read_b64_tr_b16 v[104:105], v11 offset:4096
  ds_read_b64_tr_b16 v[106:107], v11 offset:4608
  ds_read_b64_tr_b16 v[120:121], v12 offset:4096
  ds_read_b64_tr_b16 v[122:123], v12 offset:4608
  v_mfma_f32_32x32x16_bf16 v[32:47], v[172:175], v[188:191], v[32:47]
  ds_read_b64_tr_b16 v[108:109], v11 offset:6144
  ds_read_b64_tr_b16 v[110:111], v11 offset:6656
  ds_read_b64_tr_b16 v[124:125], v12 offset:6144
  ds_read_b64_tr_b16 v[126:127], v12 offset:6656
  s_barrier
  s_waitcnt lgkmcnt(0)
  v_add_u32 v11, 73728, v5
  v_add_u32 v12, 106496, v6
  v_mfma_f32_32x32x16_bf16 v[32:47], v[96:99], v[112:115], v[32:47]
  ds_read_b64_tr_b16 v[160:161], v11 offset:0
  ds_read_b64_tr_b16 v[162:163], v11 offset:512
  ds_read_b64_tr_b16 v[176:177], v12 offset:0
  ds_read_b64_tr_b16 v[178:179], v12 offset:512
  v_mfma_f32_32x32x16_bf16 v[32:47], v[100:103], v[116:119], v[32:47]
  ds_read_b64_tr_b16 v[164:165], v11 offset:2048
  ds_read_b64_tr_b16 v[166:167], v11 offset:2560
  ds_read_b64_tr_b16 v[180:181], v12 offset:2048
  ds_read_b64_tr_b16 v[182:183], v12 offset:2560
  v_mfma_f32_32x32x16_bf16 v[32:47], v[104:107], v[120:123], v[32:47]
  ds_read_b64_tr_b16 v[168:169], v11 offset:4096
  ds_read_b64_tr_b16 v[170:171], v11 offset:4608
  ds_read_b64_tr_b16 v[184:185], v12 offset:4096
  ds_read_b64_tr_b16 v[186:187], v12 offset:4608
  v_mfma_f32_32x32x16_bf16 v[32:47], v[108:111], v[124:127], v[32:47]
  ds_read_b64_tr_b16 v[172:173], v11 offset:6144
  ds_read_b64_tr_b16 v[174:175], v11 offset:6656
  ds_read_b64_tr_b16 v[188:189], v12 offset:6144
  ds_read_b64_tr_b16 v[190:191], v12 offset:6656
  s_barrier
  s_waitcnt lgkmcnt(0)
  v_mfma_f32_32x32x16_bf16 v[32:47], v[160:163], v[176:179], v[32:47]
  v_mfma_f32_32x32x16_bf16 v[32:47], v[164:167], v[180:183], v[32:47]
  v_mfma_f32_32x32x16_bf16 v[32:47], v[168:171], v[184:187], v[32:47]
  v_mfma_f32_32x32x16_bf16 v[32:47], v[172:175], v[188:191], v[32:47]
  s_waitcnt vmcnt(0)
  v_lshlrev_b32 v9, 16, v9
  v_lshlrev_b32 v2, 16, v224
  v_and_b32 v3, 0xffff0000, v224
  v_add_f32 v2, v2, v9
  v_add_f32 v3, v3, v9
  s_nop 5
  v_add_f32 v2, v2, v32
  v_add_f32 v3, v3, v33
  v_cvt_pk_bf16_f32 v96, v2, v3
  v_lshlrev_b32 v2, 16, v225
  v_and_b32 v3, 0xffff0000, v225
  v_add_f32 v2, v2, v9
  v_add_f32 v3, v3, v9
  v_add_f32 v2, v2, v34
  v_add_f32 v3, v3, v35
  v_cvt_pk_bf16_f32 v97, v2, v3
  v_lshlrev_b32 v2, 16, v226
  v_and_b32 v3, 0xffff0000, v226
  v_add_f32 v2, v2, v9
  v_add_f32 v3, v3, v9
  v_add_f32 v2, v2, v36
  v_add_f32 v3, v3, v37
  v_cvt_pk_bf16_f32 v98, v2, v3
  v_lshlrev_b32 v2, 16, v227
  v_and_b32 v3, 0xffff0000, v227
  v_add_f32 v2, v2, v9
  v_add_f32 v3, v3, v9
  v_add_f32 v2, v2, v38
  v_add_f32 v3, v3, v39
  v_cvt_pk_bf16_f32 v99, v2, v3
  v_lshlrev_b32 v2, 16, v228
  v_and_b32 v3, 0xffff0000, v228
  v_add_f32 v2, v2, v9
  v_add_f32 v3, v3, v9
  v_add_f32 v2, v2, v40
  v_add_f32 v3, v3, v41
  v_cvt_pk_bf16_f32 v100, v2, v3
  v_lshlrev_b32 v2, 16, v229
  v_and_b32 v3, 0xffff0000, v229
  v_add_f32 v2, v2, v9
  v_add_f32 v3, v3, v9
  v_add_f32 v2, v2, v42
  v_add_f32 v3, v3, v43
  v_cvt_pk_bf16_f32 v101, v2, v3
  v_lshlrev_b32 v2, 16, v230
  v_and_b32 v3, 0xffff0000, v230
  v_add_f32 v2, v2, v9
  v_add_f32 v3, v3, v9
  v_add_f32 v2, v2, v44
  v_add_f32 v3, v3, v45
  v_cvt_pk_bf16_f32 v102, v2, v3
  v_lshlrev_b32 v2, 16, v231
  v_and_b32 v3, 0xffff0000, v231
  v_add_f32 v2, v2, v9
  v_add_f32 v3, v3, v9
  v_add_f32 v2, v2, v46
  v_add_f32 v3, v3, v47
  v_cvt_pk_bf16_f32 v103, v2, v3
  v_permlane32_swap_b32 v96, v98
  v_permlane32_swap_b32 v97, v99
  v_permlane32_swap_b32 v100, v102
  v_permlane32_swap_b32 v101, v103
  buffer_store_dwordx4 v[96:99], v8, s[36:39], 0 offen offset:0
  buffer_store_dwordx4 v[100:103], v8, s[36:39], 0 offen offset:32
  s_or_b32 s52, s55, s44
  s_cmp_lg_u32 s52, 0
  s_cbranch_scc1 K_noep
  v_mov_b32 v2, 0
  v_mov_b32 v3, s51
  s_mov_b64 exec, 1
  buffer_store_dword v3, v2, s[40:43], 0 offen
  s_mov_b64 exec, -1
K_noep:
  s_endpgm
K_prod:
  s_and_b32 s44, s44, 3
  v_lshrrev_b32 v2, 3, v1
  s_lshl_b32 s52, s44, 3
  s_add_u32 s52, s52, s49
  s_sub_u32 s52, s52, 16
  v_add_u32 v2, s52, v2
  v_lshlrev_b32 v2, 10, v2
  v_lshrrev_b32 v3, 4, v1
  s_and_b32 s52, s44, 1
  s_lshl_b32 s52, s52, 2
  v_add_u32 v3, s52, v3
  v_and_b32 v4, 7, v1
  v_xor_b32 v3, v3, v4
  v_lshl_add_u32 v5, v3, 4, v2
  v_add_u32 v6, 32768, v5
  v_add_u32 v7, 65536, v5
  s_lshl_b32 s86, s44, 10
  v_lshrrev_b32 v2, 3, v1
  s_lshl_b32 s52, s44, 4
  v_add_u32 v2, s52, v2
  v_mul_u32_u24 v2, 3072, v2
  s_lshl_b32 s52, s46, 7
  v_add_u32 v2, s52, v2
  v_bfe_u32 v3, v1, 4, 1
  v_lshlrev_b32 v3, 1, v3
  v_xor_b32 v3, v3, v4
  v_lshl_add_u32 v8, v3, 4, v2
  v_xor_b32 v3, 4, v3
  v_lshl_add_u32 v9, v3, 4, v2
  v_add_u32 v9, 24576, v9
  s_lshl_b32 s87, s44, 11
  s_add_u32 s87, s87, 10240
  s_lshr_b32 s91, s55, 5
  s_mov_b32 s91, 0
  s_lshr_b32 s92, s55, 6
  s_mul_i32 s92, s92, 11
  s_lshl_b32 s93, s47, 2
  s_add_u32 s92, s92, s93
  s_lshr_b32 s93, s55, 6
  s_lshl_b32 s93, s93, 1
  s_add_u32 s93, s93, s47
  s_mul_i32 s94, s47, 11
  s_lshr_b32 s94, s94, 2
  s_waitcnt lgkmcnt(0)
  s_mov_b32 s8, s64
  s_mov_b32 s9, s65
  s_mov_b32 s10, 2097152
  s_mov_b32 s11, 0x00020000
  s_mov_b32 s12, s66
  s_mov_b32 s13, s67
  s_mov_b32 s14, 1572864
  s_mov_b32 s15, 0x00020000
  s_add_u32 s59, s91, 0
  s_and_b32 s59, s59, 7
  s_lshl_b32 s56, s59, 7
  s_mul_i32 s57, s59, 196608
  s_add_u32 s58, s57, 1024
  s_add_u32 s59, s57, 2048
  s_cmp_ge_u32 s44, 2
  s_cbranch_scc1 K_xs1
  s_add_u32 m0, s86, 8192
  s_nop 0
  buffer_load_dwordx4 v7, s[8:11], s56 offen lds
K_xs1:
  s_add_u32 m0, s86, 0
  s_nop 0
  buffer_load_dwordx4 v5, s[8:11], s56 offen lds
  s_add_u32 m0, s86, 4096
  s_nop 0
  buffer_load_dwordx4 v6, s[8:11], s56 offen lds
  s_add_u32 m0, s87, 0
  s_nop 0
  buffer_load_dwordx4 v8, s[12:15], s57 offen lds
  s_add_u32 m0, s87, 1024
  s_nop 0
  buffer_load_dwordx4 v9, s[12:15], s57 offen lds
  s_add_u32 m0, s87, 8192
  s_nop 0
  buffer_load_dwordx4 v8, s[12:15], s58 offen lds
  s_add_u32 m0, s87, 9216
  s_nop 0
  buffer_load_dwordx4 v9, s[12:15], s58 offen lds
  s_add_u32 m0, s87, 16384
  s_nop 0
  buffer_load_dwordx4 v8, s[12:15], s59 offen lds
  s_add_u32 m0, s87, 17408
  s_nop 0
  buffer_load_dwordx4 v9, s[12:15], s59 offen lds
  s_add_u32 s59, s91, 1
  s_and_b32 s59, s59, 7
  s_lshl_b32 s56, s59, 7
  s_mul_i32 s57, s59, 196608
  s_add_u32 s58, s57, 1024
  s_add_u32 s59, s57, 2048
  s_cmp_ge_u32 s44, 2
  s_cbranch_scc1 K_xs2
  s_add_u32 m0, s86, 43008
  s_nop 0
  buffer_load_dwordx4 v7, s[8:11], s56 offen lds
K_xs2:
  s_add_u32 m0, s86, 34816
  s_nop 0
  buffer_load_dwordx4 v5, s[8:11], s56 offen lds
  s_add_u32 m0, s86, 38912
  s_nop 0
  buffer_load_dwordx4 v6, s[8:11], s56 offen lds
  s_add_u32 m0, s87, 34816
  s_nop 0
  buffer_load_dwordx4 v8, s[12:15], s57 offen lds
  s_add_u32 m0, s87, 35840
  s_nop 0
  buffer_load_dwordx4 v9, s[12:15], s57 offen lds
  s_add_u32 m0, s87, 43008
  s_nop 0
  buffer_load_dwordx4 v8, s[12:15], s58 offen lds
  s_add_u32 m0, s87, 44032
  s_nop 0
  buffer_load_dwordx4 v9, s[12:15], s58 offen lds
  s_add_u32 m0, s87, 51200
  s_nop 0
  buffer_load_dwordx4 v8, s[12:15], s59 offen lds
  s_add_u32 m0, s87, 52224
  s_nop 0
  buffer_load_dwordx4 v9, s[12:15], s59 offen lds
  s_mov_b32 s20, s72
  s_mov_b32 s21, s73
  s_mov_b32 s22, 5636096
  s_mov_b32 s23, 0x00020000
  s_mov_b32 s16, s84
  s_mov_b32 s17, s85
  s_mov_b32 s18, 2359296
  s_mov_b32 s19, 0x00020000
  s_mov_b32 s24, s68
  s_mov_b32 s25, s69
  s_mov_b32 s26, 524288
  s_mov_b32 s27, 0x00020000
  s_mov_b32 s36, s76
  s_mov_b32 s37, s77
  s_mov_b32 s38, 5636096
  s_mov_b32 s39, 0x00020000
  s_add_u32 s28, s84, 4194304
  s_addc_u32 s29, s85, 0
  s_mov_b32 s30, 2162688
  s_mov_b32 s31, 0x00020000
  s_add_u32 s32, s84, 8388608
  s_addc_u32 s33, s85, 0
  s_mov_b32 s34, 1585152
  s_mov_b32 s35, 0x00020000
  s_lshl_b32 s90, s44, 11
  v_lshrrev_b32 v2, 3, v1
  s_lshl_b32 s52, s44, 4
  v_add_u32 v2, s52, v2
  v_and_b32 v4, 7, v1
  v_lshrrev_b32 v3, 4, v1
  v_lshlrev_b32 v3, 1, v3
  v_xor_b32 v3, v3, v4
  v_lshlrev_b32 v3, 4, v3
  s_lshl_b32 s52, s3, 1
  v_mul_u32_u24 v10, 1152, v2
  v_add_u32 v10, v10, v3
  v_add_u32 v10, s52, v10
  v_add_u32 v11, 9216, v10
  v_mul_u32_u24 v12, 2752, v2
  v_add_u32 v12, v12, v3
  s_lshl_b32 s52, s48, 1
  v_add_u32 v12, s52, v12
  v_add_u32 v13, 22016, v12
  s_mov_b32 s88, 73728
  s_mov_b32 s89, 176128
  v_bfe_u32 v3, v1, 4, 1
  v_lshlrev_b32 v3, 2, v3
  v_xor_b32 v3, v3, v4
  v_lshlrev_b32 v3, 4, v3
  s_lshl_b32 s52, s3, 1
  v_lshl_add_u32 v17, v2, 10, v3
  v_add_u32 v17, s52, v17
  v_add_u32 v18, 8192, v17
  s_lshl_b32 s52, s101, 1
  v_lshl_add_u32 v19, v2, 12, v3
  v_add_u32 v19, s52, v19
  v_add_u32 v20, 32768, v19
  v_mul_u32_u24 v21, 4224, v2
  v_add_u32 v21, v21, v3
  v_add_u32 v21, s52, v21
  v_add_u32 v22, 33792, v21
  s_lshl_b32 s52, s3, 1
  v_mul_u32_u24 v23, 1152, v2
  v_add_u32 v23, v23, v3
  v_add_u32 v23, s52, v23
  v_add_u32 v24, 9216, v23
  s_waitcnt vmcnt(8)
  s_barrier
  s_add_u32 s59, s91, 2
  s_and_b32 s59, s59, 7
  s_lshl_b32 s56, s59, 7
  s_mul_i32 s57, s59, 196608
  s_add_u32 s58, s57, 1024
  s_add_u32 s59, s57, 2048
  s_cmp_ge_u32 s44, 2
  s_cbranch_scc1 K_xs3
  s_add_u32 m0, s86, 77824
  s_nop 0
  buffer_load_dwordx4 v7, s[8:11], s56 offen lds
K_xs3:
  s_add_u32 m0, s86, 69632
  s_nop 0
  buffer_load_dwordx4 v5, s[8:11], s56 offen lds
  s_add_u32 m0, s86, 73728
  s_nop 0
  buffer_load_dwordx4 v6, s[8:11], s56 offen lds
  s_add_u32 m0, s87, 69632
  s_nop 0
  buffer_load_dwordx4 v8, s[12:15], s57 offen lds
  s_add_u32 m0, s87, 70656
  s_nop 0
  buffer_load_dwordx4 v9, s[12:15], s57 offen lds
  s_add_u32 m0, s87, 77824
  s_nop 0
  buffer_load_dwordx4 v8, s[12:15], s58 offen lds
  s_add_u32 m0, s87, 78848
  s_nop 0
  buffer_load_dwordx4 v9, s[12:15], s58 offen lds
  s_add_u32 m0, s87, 86016
  s_nop 0
  buffer_load_dwordx4 v8, s[12:15], s59 offen lds
  s_add_u32 m0, s87, 87040
  s_nop 0
  buffer_load_dwordx4 v9, s[12:15], s59 offen lds
  s_add_u32 s59, s91, 3
  s_and_b32 s59, s59, 7
  s_lshl_b32 s56, s59, 7
  s_mul_i32 s57, s59, 196608
  s_add_u32 s58, s57, 1024
  s_add_u32 s59, s57, 2048
  s_cmp_ge_u32 s44, 2
  s_cbranch_scc1 K_xs4
  s_add_u32 m0, s86, 112640
  s_nop 0
  buffer_load_dwordx4 v7, s[8:11], s56 offen lds
K_xs4:
  s_add_u32 m0, s86, 104448
  s_nop 0
  buffer_load_dwordx4 v5, s[8:11], s56 offen lds
  s_add_u32 m0, s86, 108544
  s_nop 0
  buffer_load_dwordx4 v6, s[8:11], s56 offen lds
  s_add_u32 m0, s87, 104448
  s_nop 0
  buffer_load_dwordx4 v8, s[12:15], s57 offen lds
  s_add_u32 m0, s87, 105472
  s_nop 0
  buffer_load_dwordx4 v9, s[12:15], s57 offen lds
  s_add_u32 m0, s87, 112640
  s_nop 0
  buffer_load_dwordx4 v8, s[12:15], s58 offen lds
  s_add_u32 m0, s87, 113664
  s_nop 0
  buffer_load_dwordx4 v9, s[12:15], s58 offen lds
  s_add_u32 m0, s87, 120832
  s_nop 0
  buffer_load_dwordx4 v8, s[12:15], s59 offen lds
  s_add_u32 m0, s87, 121856
  s_nop 0
  buffer_load_dwordx4 v9, s[12:15], s59 offen lds
  s_waitcnt vmcnt(16)
  s_barrier
  s_add_u32 s59, s91, 4
  s_and_b32 s59, s59, 7
  s_lshl_b32 s56, s59, 7
  s_mul_i32 s57, s59, 196608
  s_add_u32 s58, s57, 1024
  s_add_u32 s59, s57, 2048
  s_cmp_ge_u32 s44, 2
  s_cbranch_scc1 K_xs5
  s_add_u32 m0, s86, 8192
  s_nop 0
  buffer_load_dwordx4 v7, s[8:11], s56 offen lds
K_xs5:
  s_add_u32 m0, s86, 0
  s_nop 0
  buffer_load_dwordx4 v5, s[8:11], s56 offen lds
  s_add_u32 m0, s86, 4096
  s_nop 0
  buffer_load_dwordx4 v6, s[8:11], s56 offen lds
  s_add_u32 m0, s87, 0
  s_nop 0
  buffer_load_dwordx4 v8, s[12:15], s57 offen lds
  s_add_u32 m0, s87, 1024
  s_nop 0
  buffer_load_dwordx4 v9, s[12:15], s57 offen lds
  s_add_u32 m0, s87, 8192
  s_nop 0
  buffer_load_dwordx4 v8, s[12:15], s58 offen lds
  s_add_u32 m0, s87, 9216
  s_nop 0
  buffer_load_dwordx4 v9, s[12:15], s58 offen lds
  s_add_u32 m0, s87, 16384
  s_nop 0
  buffer_load_dwordx4 v8, s[12:15], s59 offen lds
  s_add_u32 m0, s87, 17408
  s_nop 0
  buffer_load_dwordx4 v9, s[12:15], s59 offen lds
  s_waitcnt vmcnt(16)
  s_barrier
  s_add_u32 s59, s91, 5
  s_and_b32 s59, s59, 7
  s_lshl_b32 s56, s59, 7
  s_mul_i32 s57, s59, 196608
  s_add_u32 s58, s57, 1024
  s_add_u32 s59, s57, 2048
  s_cmp_ge_u32 s44, 2
  s_cbranch_scc1 K_xs6
  s_add_u32 m0, s86, 43008
  s_nop 0
  buffer_load_dwordx4 v7, s[8:11], s56 offen lds
K_xs6:
  s_add_u32 m0, s86, 34816
  s_nop 0
  buffer_load_dwordx4 v5, s[8:11], s56 offen lds
  s_add_u32 m0, s86, 38912
  s_nop 0
  buffer_load_dwordx4 v6, s[8:11], s56 offen lds
  s_add_u32 m0, s87, 34816
  s_nop 0
  buffer_load_dwordx4 v8, s[12:15], s57 offen lds
  s_add_u32 m0, s87, 35840
  s_nop 0
  buffer_load_dwordx4 v9, s[12:15], s57 offen lds
  s_add_u32 m0, s87, 43008
  s_nop 0
  buffer_load_dwordx4 v8, s[12:15], s58 offen lds
  s_add_u32 m0, s87, 44032
  s_nop 0
  buffer_load_dwordx4 v9, s[12:15], s58 offen lds
  s_add_u32 m0, s87, 51200
  s_nop 0
  buffer_load_dwordx4 v8, s[12:15], s59 offen lds
  s_add_u32 m0, s87, 52224
  s_nop 0
  buffer_load_dwordx4 v9, s[12:15], s59 offen lds
  s_waitcnt vmcnt(16)
  s_barrier
  s_add_u32 s59, s91, 6
  s_and_b32 s59, s59, 7
  s_lshl_b32 s56, s59, 7
  s_mul_i32 s57, s59, 196608
  s_add_u32 s58, s57, 1024
  s_add_u32 s59, s57, 2048
  s_cmp_ge_u32 s44, 2
  s_cbranch_scc1 K_xs7
  s_add_u32 m0, s86, 77824
  s_nop 0
  buffer_load_dwordx4 v7, s[8:11], s56 offen lds
K_xs7:
  s_add_u32 m0, s86, 69632
  s_nop 0
  buffer_load_dwordx4 v5, s[8:11], s56 offen lds
  s_add_u32 m0, s86, 73728
  s_nop 0
  buffer_load_dwordx4 v6, s[8:11], s56 offen lds
  s_add_u32 m0, s87, 69632
  s_nop 0
  buffer_load_dwordx4 v8, s[12:15], s57 offen lds
  s_add_u32 m0, s87, 70656
  s_nop 0
  buffer_load_dwordx4 v9, s[12:15], s57 offen lds
  s_add_u32 m0, s87, 77824
  s_nop 0
  buffer_load_dwordx4 v8, s[12:15], s58 offen lds
  s_add_u32 m0, s87, 78848
  s_nop 0
  buffer_load_dwordx4 v9, s[12:15], s58 offen lds
  s_add_u32 m0, s87, 86016
  s_nop 0
  buffer_load_dwordx4 v8, s[12:15], s59 offen lds
  s_add_u32 m0, s87, 87040
  s_nop 0
  buffer_load_dwordx4 v9, s[12:15], s59 offen lds
  s_waitcnt vmcnt(16)
  s_barrier
  s_add_u32 s59, s91, 7
  s_and_b32 s59, s59, 7
  s_lshl_b32 s56, s59, 7
  s_mul_i32 s57, s59, 196608
  s_add_u32 s58, s57, 1024
  s_add_u32 s59, s57, 2048
  s_cmp_ge_u32 s44, 2
  s_cbranch_scc1 K_xs8
  s_add_u32 m0, s86, 112640
  s_nop 0
  buffer_load_dwordx4 v7, s[8:11], s56 offen lds
K_xs8:
  s_add_u32 m0, s86, 104448
  s_nop 0
  buffer_load_dwordx4 v5, s[8:11], s56 offen lds
  s_add_u32 m0, s86, 108544
  s_nop 0
  buffer_load_dwordx4 v6, s[8:11], s56 offen lds
  s_add_u32 m0, s87, 104448
  s_nop 0
  buffer_load_dwordx4 v8, s[12:15], s57 offen lds
  s_add_u32 m0, s87, 105472
  s_nop 0
  buffer_load_dwordx4 v9, s[12:15], s57 offen lds
  s_add_u32 m0, s87, 112640
  s_nop 0
  buffer_load_dwordx4 v8, s[12:15], s58 offen lds
  s_add_u32 m0, s87, 113664
  s_nop 0
  buffer_load_dwordx4 v9, s[12:15], s58 offen lds
  s_add_u32 m0, s87, 120832
  s_nop 0
  buffer_load_dwordx4 v8, s[12:15], s59 offen lds
  s_add_u32 m0, s87, 121856
  s_nop 0
  buffer_load_dwordx4 v9, s[12:15], s59 offen lds
  s_add_u32 s56, s92, 0
  s_and_b32 s56, s56, 31
  s_mul_i32 s56, s56, s89
  s_add_u32 m0, s90, 139264
  s_nop 0
  buffer_load_dwordx4 v12, s[20:23], s56 offen lds
  s_add_u32 m0, s90, 140288
  s_nop 0
  buffer_load_dwordx4 v13, s[20:23], s56 offen lds
  s_waitcnt vmcnt(18)
  s_barrier
  s_add_u32 s56, s92, 1
  s_and_b32 s56, s56, 31
  s_mul_i32 s56, s56, s89
  s_add_u32 m0, s90, 0
  s_nop 0
  buffer_load_dwordx4 v12, s[20:23], s56 offen lds
  s_add_u32 m0, s90, 1024
  s_nop 0
  buffer_load_dwordx4 v13, s[20:23], s56 offen lds
  s_waitcnt vmcnt(12)
  s_barrier
  s_add_u32 s56, s92, 2
  s_and_b32 s56, s56, 31
  s_mul_i32 s56, s56, s89
  s_add_u32 m0, s90, 8192
  s_nop 0
  buffer_load_dwordx4 v12, s[20:23], s56 offen lds
  s_add_u32 m0, s90, 9216
  s_nop 0
  buffer_load_dwordx4 v13, s[20:23], s56 offen lds
  s_waitcnt vmcnt(6)
  s_barrier
  s_add_u32 s56, s92, 0
  s_and_b32 s56, s56, 31
  s_mul_i32 s56, s56, s88
  s_add_u32 m0, s90, 16384
  s_nop 0
  buffer_load_dwordx4 v10, s[16:19], s56 offen sc1 lds
  s_add_u32 m0, s90, 17408
  s_nop 0
  buffer_load_dwordx4 v11, s[16:19], s56 offen sc1 lds
  s_add_u32 s56, s92, 1
  s_and_b32 s56, s56, 31
  s_mul_i32 s56, s56, s88
  s_add_u32 m0, s90, 24576
  s_nop 0
  buffer_load_dwordx4 v10, s[16:19], s56 offen sc1 lds
  s_add_u32 m0, s90, 25600
  s_nop 0
  buffer_load_dwordx4 v11, s[16:19], s56 offen sc1 lds
  s_add_u32 s56, s92, 2
  s_and_b32 s56, s56, 31
  s_mul_i32 s56, s56, s88
  s_add_u32 m0, s90, 32768
  s_nop 0
  buffer_load_dwordx4 v10, s[16:19], s56 offen sc1 lds
  s_add_u32 m0, s90, 33792
  s_nop 0
  buffer_load_dwordx4 v11, s[16:19], s56 offen sc1 lds
  s_waitcnt vmcnt(4)
  s_barrier
  s_add_u32 s56, s92, 3
  s_and_b32 s56, s56, 31
  s_mul_i32 s56, s56, s88
  s_add_u32 m0, s90, 40960
  s_nop 0
  buffer_load_dwordx4 v10, s[16:19], s56 offen sc1 lds
  s_add_u32 m0, s90, 41984
  s_nop 0
  buffer_load_dwordx4 v11, s[16:19], s56 offen sc1 lds
  s_add_u32 s56, s92, 3
  s_and_b32 s56, s56, 31
  s_mul_i32 s56, s56, s89
  s_add_u32 m0, s90, 49152
  s_nop 0
  buffer_load_dwordx4 v12, s[20:23], s56 offen lds
  s_add_u32 m0, s90, 50176
  s_nop 0
  buffer_load_dwordx4 v13, s[20:23], s56 offen lds
  s_add_u32 s56, s92, 4
  s_and_b32 s56, s56, 31
  s_mul_i32 s56, s56, s88
  s_add_u32 m0, s90, 57344
  s_nop 0
  buffer_load_dwordx4 v10, s[16:19], s56 offen sc1 lds
  s_add_u32 m0, s90, 58368
  s_nop 0
  buffer_load_dwordx4 v11, s[16:19], s56 offen sc1 lds
  s_waitcnt vmcnt(8)
  s_barrier
  s_add_u32 s56, s92, 4
  s_and_b32 s56, s56, 31
  s_mul_i32 s56, s56, s89
  s_add_u32 m0, s90, 65536
  s_nop 0
  buffer_load_dwordx4 v12, s[20:23], s56 offen lds
  s_add_u32 m0, s90, 66560
  s_nop 0
  buffer_load_dwordx4 v13, s[20:23], s56 offen lds
  s_add_u32 s56, s92, 5
  s_and_b32 s56, s56, 31
  s_mul_i32 s56, s56, s88
  s_add_u32 m0, s90, 73728
  s_nop 0
  buffer_load_dwordx4 v10, s[16:19], s56 offen sc1 lds
  s_add_u32 m0, s90, 74752
  s_nop 0
  buffer_load_dwordx4 v11, s[16:19], s56 offen sc1 lds
  s_add_u32 s56, s92, 5
  s_and_b32 s56, s56, 31
  s_mul_i32 s56, s56, s89
  s_add_u32 m0, s90, 81920
  s_nop 0
  buffer_load_dwordx4 v12, s[20:23], s56 offen lds
  s_add_u32 m0, s90, 82944
  s_nop 0
  buffer_load_dwordx4 v13, s[20:23], s56 offen lds
  s_waitcnt vmcnt(12)
  s_barrier
  s_add_u32 s56, s92, 6
  s_and_b32 s56, s56, 31
  s_mul_i32 s56, s56, s88
  s_add_u32 m0, s90, 16384
  s_nop 0
  buffer_load_dwordx4 v10, s[16:19], s56 offen sc1 lds
  s_add_u32 m0, s90, 17408
  s_nop 0
  buffer_load_dwordx4 v11, s[16:19], s56 offen sc1 lds
  s_add_u32 s56, s92, 6
  s_and_b32 s56, s56, 31
  s_mul_i32 s56, s56, s89
  s_add_u32 m0, s90, 90112
  s_nop 0
  buffer_load_dwordx4 v12, s[20:23], s56 offen lds
  s_add_u32 m0, s90, 91136
  s_nop 0
  buffer_load_dwordx4 v13, s[20:23], s56 offen lds
  s_add_u32 s56, s92, 7
  s_and_b32 s56, s56, 31
  s_mul_i32 s56, s56, s88
  s_add_u32 m0, s90, 98304
  s_nop 0
  buffer_load_dwordx4 v10, s[16:19], s56 offen sc1 lds
  s_add_u32 m0, s90, 99328
  s_nop 0
  buffer_load_dwordx4 v11, s[16:19], s56 offen sc1 lds
  s_waitcnt vmcnt(14)
  s_barrier
  s_add_u32 s56, s92, 7
  s_and_b32 s56, s56, 31
  s_mul_i32 s56, s56, s89
  s_add_u32 m0, s90, 0
  s_nop 0
  buffer_load_dwordx4 v12, s[20:23], s56 offen lds
  s_add_u32 m0, s90, 1024
  s_nop 0
  buffer_load_dwordx4 v13, s[20:23], s56 offen lds
  s_add_u32 s56, s92, 8
  s_and_b32 s56, s56, 31
  s_mul_i32 s56, s56, s88
  s_add_u32 m0, s90, 24576
  s_nop 0
  buffer_load_dwordx4 v10, s[16:19], s56 offen sc1 lds
  s_add_u32 m0, s90, 25600
  s_nop 0
  buffer_load_dwordx4 v11, s[16:19], s56 offen sc1 lds
  s_add_u32 s56, s92, 8
  s_and_b32 s56, s56, 31
  s_mul_i32 s56, s56, s89
  s_add_u32 m0, s90, 106496
  s_nop 0
  buffer_load_dwordx4 v12, s[20:23], s56 offen lds
  s_add_u32 m0, s90, 107520
  s_nop 0
  buffer_load_dwordx4 v13, s[20:23], s56 offen lds
  s_waitcnt vmcnt(16)
  s_barrier
  s_add_u32 s56, s92, 9
  s_and_b32 s56, s56, 31
  s_mul_i32 s56, s56, s88
  s_add_u32 m0, s90, 8192
  s_nop 0
  buffer_load_dwordx4 v10, s[16:19], s56 offen sc1 lds
  s_add_u32 m0, s90, 9216
  s_nop 0
  buffer_load_dwordx4 v11, s[16:19], s56 offen sc1 lds
  s_add_u32 s56, s92, 9
  s_and_b32 s56, s56, 31
  s_mul_i32 s56, s56, s89
  s_add_u32 m0, s90, 32768
  s_nop 0
  buffer_load_dwordx4 v12, s[20:23], s56 offen lds
  s_add_u32 m0, s90, 33792
  s_nop 0
  buffer_load_dwordx4 v13, s[20:23], s56 offen lds
  s_add_u32 s56, s92, 10
  s_and_b32 s56, s56, 31
  s_mul_i32 s56, s56, s88
  s_add_u32 m0, s90, 114688
  s_nop 0
  buffer_load_dwordx4 v10, s[16:19], s56 offen sc1 lds
  s_add_u32 m0, s90, 115712
  s_nop 0
  buffer_load_dwordx4 v11, s[16:19], s56 offen sc1 lds
  s_waitcnt vmcnt(18)
  s_barrier
  s_add_u32 s56, s92, 10
  s_and_b32 s56, s56, 31
  s_mul_i32 s56, s56, s89
  s_add_u32 m0, s90, 40960
  s_nop 0
  buffer_load_dwordx4 v12, s[20:23], s56 offen lds
  s_add_u32 m0, s90, 41984
  s_nop 0
  buffer_load_dwordx4 v13, s[20:23], s56 offen lds
  s_add_u32 s56, s92, 11
  s_and_b32 s56, s56, 31
  s_mul_i32 s56, s56, s88
  s_add_u32 m0, s90, 49152
  s_nop 0
  buffer_load_dwordx4 v10, s[16:19], s56 offen sc1 lds
  s_add_u32 m0, s90, 50176
  s_nop 0
  buffer_load_dwordx4 v11, s[16:19], s56 offen sc1 lds
  s_waitcnt vmcnt(18)
  s_barrier
  s_add_u32 s56, s92, 11
  s_and_b32 s56, s56, 31
  s_mul_i32 s56, s56, s89
  s_add_u32 m0, s90, 57344
  s_nop 0
  buffer_load_dwordx4 v12, s[20:23], s56 offen lds
  s_add_u32 m0, s90, 58368
  s_nop 0
  buffer_load_dwordx4 v13, s[20:23], s56 offen lds
  s_add_u32 s56, s92, 12
  s_and_b32 s56, s56, 31
  s_mul_i32 s56, s56, s88
  s_add_u32 m0, s90, 65536
  s_nop 0
  buffer_load_dwordx4 v10, s[16:19], s56 offen sc1 lds
  s_add_u32 m0, s90, 66560
  s_nop 0
  buffer_load_dwordx4 v11, s[16:19], s56 offen sc1 lds
  s_waitcnt vmcnt(18)
  s_barrier
  s_add_u32 s56, s92, 12
  s_and_b32 s56, s56, 31
  s_mul_i32 s56, s56, s89
  s_add_u32 m0, s90, 73728
  s_nop 0
  buffer_load_dwordx4 v12, s[20:23], s56 offen lds
  s_add_u32 m0, s90, 74752
  s_nop 0
  buffer_load_dwordx4 v13, s[20:23], s56 offen lds
  s_add_u32 s56, s92, 13
  s_and_b32 s56, s56, 31
  s_mul_i32 s56, s56, s88
  s_add_u32 m0, s90, 81920
  s_nop 0
  buffer_load_dwordx4 v10, s[16:19], s56 offen sc1 lds
  s_add_u32 m0, s90, 82944
  s_nop 0
  buffer_load_dwordx4 v11, s[16:19], s56 offen sc1 lds
  s_waitcnt vmcnt(18)
  s_barrier
  s_add_u32 s56, s92, 13
  s_and_b32 s56, s56, 31
  s_mul_i32 s56, s56, s89
  s_add_u32 m0, s90, 16384
  s_nop 0
  buffer_load_dwordx4 v12, s[20:23], s56 offen lds
  s_add_u32 m0, s90, 17408
  s_nop 0
  buffer_load_dwordx4 v13, s[20:23], s56 offen lds
  s_add_u32 s56, s92, 14
  s_and_b32 s56, s56, 31
  s_mul_i32 s56, s56, s88
  s_add_u32 m0, s90, 90112
  s_nop 0
  buffer_load_dwordx4 v10, s[16:19], s56 offen sc1 lds
  s_add_u32 m0, s90, 91136
  s_nop 0
  buffer_load_dwordx4 v11, s[16:19], s56 offen sc1 lds
  s_waitcnt vmcnt(18)
  s_barrier
  s_add_u32 s56, s92, 14
  s_and_b32 s56, s56, 31
  s_mul_i32 s56, s56, s89
  s_add_u32 m0, s90, 0
  s_nop 0
  buffer_load_dwordx4 v12, s[20:23], s56 offen lds
  s_add_u32 m0, s90, 1024
  s_nop 0
  buffer_load_dwordx4 v13, s[20:23], s56 offen lds
  s_add_u32 s56, s92, 15
  s_and_b32 s56, s56, 31
  s_mul_i32 s56, s56, s88
  s_add_u32 m0, s90, 98304
  s_nop 0
  buffer_load_dwordx4 v10, s[16:19], s56 offen sc1 lds
  s_add_u32 m0, s90, 99328
  s_nop 0
  buffer_load_dwordx4 v11, s[16:19], s56 offen sc1 lds
  s_waitcnt vmcnt(18)
  s_barrier
  s_add_u32 s56, s92, 15
  s_and_b32 s56, s56, 31
  s_mul_i32 s56, s56, s89
  s_add_u32 m0, s90, 24576
  s_nop 0
  buffer_load_dwordx4 v12, s[20:23], s56 offen lds
  s_add_u32 m0, s90, 25600
  s_nop 0
  buffer_load_dwordx4 v13, s[20:23], s56 offen lds
  s_add_u32 s56, s92, 16
  s_and_b32 s56, s56, 31
  s_mul_i32 s56, s56, s88
  s_add_u32 m0, s90, 106496
  s_nop 0
  buffer_load_dwordx4 v10, s[16:19], s56 offen sc1 lds
  s_add_u32 m0, s90, 107520
  s_nop 0
  buffer_load_dwordx4 v11, s[16:19], s56 offen sc1 lds
  s_waitcnt vmcnt(18)
  s_barrier
  s_add_u32 s56, s92, 16
  s_and_b32 s56, s56, 31
  s_mul_i32 s56, s56, s89
  s_add_u32 m0, s90, 8192
  s_nop 0
  buffer_load_dwordx4 v12, s[20:23], s56 offen lds
  s_add_u32 m0, s90, 9216
  s_nop 0
  buffer_load_dwordx4 v13, s[20:23], s56 offen lds
  s_add_u32 s56, s92, 17
  s_and_b32 s56, s56, 31
  s_mul_i32 s56, s56, s88
  s_add_u32 m0, s90, 32768
  s_nop 0
  buffer_load_dwordx4 v10, s[16:19], s56 offen sc1 lds
  s_add_u32 m0, s90, 33792
  s_nop 0
  buffer_load_dwordx4 v11, s[16:19], s56 offen sc1 lds
  s_waitcnt vmcnt(18)
  s_barrier
  s_add_u32 s56, s92, 17
  s_and_b32 s56, s56, 31
  s_mul_i32 s56, s56, s89
  s_add_u32 m0, s90, 40960
  s_nop 0
  buffer_load_dwordx4 v12, s[20:23], s56 offen lds
  s_add_u32 m0, s90, 41984
  s_nop 0
  buffer_load_dwordx4 v13, s[20:23], s56 offen lds
  s_add_u32 s56, s92, 18
  s_and_b32 s56, s56, 31
  s_mul_i32 s56, s56, s88
  s_add_u32 m0, s90, 114688
  s_nop 0
  buffer_load_dwordx4 v10, s[16:19], s56 offen sc1 lds
  s_add_u32 m0, s90, 115712
  s_nop 0
  buffer_load_dwordx4 v11, s[16:19], s56 offen sc1 lds
  s_waitcnt vmcnt(18)
  s_barrier
  s_add_u32 s56, s92, 18
  s_and_b32 s56, s56, 31
  s_mul_i32 s56, s56, s89
  s_add_u32 m0, s90, 49152
  s_nop 0
  buffer_load_dwordx4 v12, s[20:23], s56 offen lds
  s_add_u32 m0, s90, 50176
  s_nop 0
  buffer_load_dwordx4 v13, s[20:23], s56 offen lds
  s_add_u32 s56, s92, 19
  s_and_b32 s56, s56, 31
  s_mul_i32 s56, s56, s88
  s_add_u32 m0, s90, 57344
  s_nop 0
  buffer_load_dwordx4 v10, s[16:19], s56 offen sc1 lds
  s_add_u32 m0, s90, 58368
  s_nop 0
  buffer_load_dwordx4 v11, s[16:19], s56 offen sc1 lds
  s_waitcnt vmcnt(18)
  s_barrier
  s_add_u32 s56, s92, 19
  s_and_b32 s56, s56, 31
  s_mul_i32 s56, s56, s89
  s_add_u32 m0, s90, 65536
  s_nop 0
  buffer_load_dwordx4 v12, s[20:23], s56 offen lds
  s_add_u32 m0, s90, 66560
  s_nop 0
  buffer_load_dwordx4 v13, s[20:23], s56 offen lds
  s_add_u32 s56, s92, 20
  s_and_b32 s56, s56, 31
  s_mul_i32 s56, s56, s88
  s_add_u32 m0, s90, 73728
  s_nop 0
  buffer_load_dwordx4 v10, s[16:19], s56 offen sc1 lds
  s_add_u32 m0, s90, 74752
  s_nop 0
  buffer_load_dwordx4 v11, s[16:19], s56 offen sc1 lds
  s_waitcnt vmcnt(18)
  s_barrier
  s_add_u32 s56, s92, 20
  s_and_b32 s56, s56, 31
  s_mul_i32 s56, s56, s89
  s_add_u32 m0, s90, 16384
  s_nop 0
  buffer_load_dwordx4 v12, s[20:23], s56 offen lds
  s_add_u32 m0, s90, 17408
  s_nop 0
  buffer_load_dwordx4 v13, s[20:23], s56 offen lds
  s_add_u32 s56, s92, 21
  s_and_b32 s56, s56, 31
  s_mul_i32 s56, s56, s88
  s_add_u32 m0, s90, 81920
  s_nop 0
  buffer_load_dwordx4 v10, s[16:19], s56 offen sc1 lds
  s_add_u32 m0, s90, 82944
  s_nop 0
  buffer_load_dwordx4 v11, s[16:19], s56 offen sc1 lds
  s_waitcnt vmcnt(18)
  s_barrier
  s_add_u32 s56, s92, 21
  s_and_b32 s56, s56, 31
  s_mul_i32 s56, s56, s89
  s_add_u32 m0, s90, 0
  s_nop 0
  buffer_load_dwordx4 v12, s[20:23], s56 offen lds
  s_add_u32 m0, s90, 1024
  s_nop 0
  buffer_load_dwordx4 v13, s[20:23], s56 offen lds
  s_add_u32 s56, s92, 22
  s_and_b32 s56, s56, 31
  s_mul_i32 s56, s56, s88
  s_add_u32 m0, s90, 90112
  s_nop 0
  buffer_load_dwordx4 v10, s[16:19], s56 offen sc1 lds
  s_add_u32 m0, s90, 91136
  s_nop 0
  buffer_load_dwordx4 v11, s[16:19], s56 offen sc1 lds
  s_waitcnt vmcnt(18)
  s_barrier
  s_add_u32 s56, s92, 22
  s_and_b32 s56, s56, 31
  s_mul_i32 s56, s56, s89
  s_add_u32 m0, s90, 24576
  s_nop 0
  buffer_load_dwordx4 v12, s[20:23], s56 offen lds
  s_add_u32 m0, s90, 25600
  s_nop 0
  buffer_load_dwordx4 v13, s[20:23], s56 offen lds
  s_add_u32 s56, s92, 23
  s_and_b32 s56, s56, 31
  s_mul_i32 s56, s56, s88
  s_add_u32 m0, s90, 98304
  s_nop 0
  buffer_load_dwordx4 v10, s[16:19], s56 offen sc1 lds
  s_add_u32 m0, s90, 99328
  s_nop 0
  buffer_load_dwordx4 v11, s[16:19], s56 offen sc1 lds
  s_waitcnt vmcnt(18)
  s_barrier
  s_add_u32 s56, s92, 23
  s_and_b32 s56, s56, 31
  s_mul_i32 s56, s56, s89
  s_add_u32 m0, s90, 8192
  s_nop 0
  buffer_load_dwordx4 v12, s[20:23], s56 offen lds
  s_add_u32 m0, s90, 9216
  s_nop 0
  buffer_load_dwordx4 v13, s[20:23], s56 offen lds
  s_add_u32 s56, s92, 24
  s_and_b32 s56, s56, 31
  s_mul_i32 s56, s56, s88
  s_add_u32 m0, s90, 106496
  s_nop 0
  buffer_load_dwordx4 v10, s[16:19], s56 offen sc1 lds
  s_add_u32 m0, s90, 107520
  s_nop 0
  buffer_load_dwordx4 v11, s[16:19], s56 offen sc1 lds
  s_waitcnt vmcnt(18)
  s_barrier
  s_add_u32 s56, s92, 24
  s_and_b32 s56, s56, 31
  s_mul_i32 s56, s56, s89
  s_add_u32 m0, s90, 32768
  s_nop 0
  buffer_load_dwordx4 v12, s[20:23], s56 offen lds
  s_add_u32 m0, s90, 33792
  s_nop 0
  buffer_load_dwordx4 v13, s[20:23], s56 offen lds
  s_add_u32 s56, s92, 25
  s_and_b32 s56, s56, 31
  s_mul_i32 s56, s56, s88
  s_add_u32 m0, s90, 40960
  s_nop 0
  buffer_load_dwordx4 v10, s[16:19], s56 offen sc1 lds
  s_add_u32 m0, s90, 41984
  s_nop 0
  buffer_load_dwordx4 v11, s[16:19], s56 offen sc1 lds
  s_waitcnt vmcnt(18)
  s_barrier
  s_add_u32 s56, s92, 25
  s_and_b32 s56, s56, 31
  s_mul_i32 s56, s56, s89
  s_add_u32 m0, s90, 49152
  s_nop 0
  buffer_load_dwordx4 v12, s[20:23], s56 offen lds
  s_add_u32 m0, s90, 50176
  s_nop 0
  buffer_load_dwordx4 v13, s[20:23], s56 offen lds
  s_add_u32 s56, s92, 26
  s_and_b32 s56, s56, 31
  s_mul_i32 s56, s56, s88
  s_add_u32 m0, s90, 114688
  s_nop 0
  buffer_load_dwordx4 v10, s[16:19], s56 offen sc1 lds
  s_add_u32 m0, s90, 115712
  s_nop 0
  buffer_load_dwordx4 v11, s[16:19], s56 offen sc1 lds
  s_waitcnt vmcnt(18)
  s_barrier
  s_add_u32 s56, s92, 26
  s_and_b32 s56, s56, 31
  s_mul_i32 s56, s56, s89
  s_add_u32 m0, s90, 57344
  s_nop 0
  buffer_load_dwordx4 v12, s[20:23], s56 offen lds
  s_add_u32 m0, s90, 58368
  s_nop 0
  buffer_load_dwordx4 v13, s[20:23], s56 offen lds
  s_add_u32 s56, s92, 27
  s_and_b32 s56, s56, 31
  s_mul_i32 s56, s56, s88
  s_add_u32 m0, s90, 65536
  s_nop 0
  buffer_load_dwordx4 v10, s[16:19], s56 offen sc1 lds
  s_add_u32 m0, s90, 66560
  s_nop 0
  buffer_load_dwordx4 v11, s[16:19], s56 offen sc1 lds
  s_waitcnt vmcnt(18)
  s_barrier
  s_add_u32 s56, s92, 27
  s_and_b32 s56, s56, 31
  s_mul_i32 s56, s56, s89
  s_add_u32 m0, s90, 16384
  s_nop 0
  buffer_load_dwordx4 v12, s[20:23], s56 offen lds
  s_add_u32 m0, s90, 17408
  s_nop 0
  buffer_load_dwordx4 v13, s[20:23], s56 offen lds
  s_add_u32 s56, s92, 28
  s_and_b32 s56, s56, 31
  s_mul_i32 s56, s56, s88
  s_add_u32 m0, s90, 73728
  s_nop 0
  buffer_load_dwordx4 v10, s[16:19], s56 offen sc1 lds
  s_add_u32 m0, s90, 74752
  s_nop 0
  buffer_load_dwordx4 v11, s[16:19], s56 offen sc1 lds
  s_waitcnt vmcnt(18)
  s_barrier
  s_add_u32 s56, s92, 28
  s_and_b32 s56, s56, 31
  s_mul_i32 s56, s56, s89
  s_add_u32 m0, s90, 0
  s_nop 0
  buffer_load_dwordx4 v12, s[20:23], s56 offen lds
  s_add_u32 m0, s90, 1024
  s_nop 0
  buffer_load_dwordx4 v13, s[20:23], s56 offen lds
  s_add_u32 s56, s92, 29
  s_and_b32 s56, s56, 31
  s_mul_i32 s56, s56, s88
  s_add_u32 m0, s90, 81920
  s_nop 0
  buffer_load_dwordx4 v10, s[16:19], s56 offen sc1 lds
  s_add_u32 m0, s90, 82944
  s_nop 0
  buffer_load_dwordx4 v11, s[16:19], s56 offen sc1 lds
  s_waitcnt vmcnt(18)
  s_barrier
  s_add_u32 s56, s92, 29
  s_and_b32 s56, s56, 31
  s_mul_i32 s56, s56, s89
  s_add_u32 m0, s90, 24576
  s_nop 0
  buffer_load_dwordx4 v12, s[20:23], s56 offen lds
  s_add_u32 m0, s90, 25600
  s_nop 0
  buffer_load_dwordx4 v13, s[20:23], s56 offen lds
  s_add_u32 s56, s92, 30
  s_and_b32 s56, s56, 31
  s_mul_i32 s56, s56, s88
  s_add_u32 m0, s90, 90112
  s_nop 0
  buffer_load_dwordx4 v10, s[16:19], s56 offen sc1 lds
  s_add_u32 m0, s90, 91136
  s_nop 0
  buffer_load_dwordx4 v11, s[16:19], s56 offen sc1 lds
  s_waitcnt vmcnt(18)
  s_barrier
  s_add_u32 s56, s92, 30
  s_and_b32 s56, s56, 31
  s_mul_i32 s56, s56, s89
  s_add_u32 m0, s90, 8192
  s_nop 0
  buffer_load_dwordx4 v12, s[20:23], s56 offen lds
  s_add_u32 m0, s90, 9216
  s_nop 0
  buffer_load_dwordx4 v13, s[20:23], s56 offen lds
  s_add_u32 s56, s92, 31
  s_and_b32 s56, s56, 31
  s_mul_i32 s56, s56, s88
  s_add_u32 m0, s90, 98304
  s_nop 0
  buffer_load_dwordx4 v10, s[16:19], s56 offen sc1 lds
  s_add_u32 m0, s90, 99328
  s_nop 0
  buffer_load_dwordx4 v11, s[16:19], s56 offen sc1 lds
  s_waitcnt vmcnt(18)
  s_barrier
  s_add_u32 s56, s92, 31
  s_and_b32 s56, s56, 31
  s_mul_i32 s56, s56, s89
  s_add_u32 m0, s90, 32768
  s_nop 0
  buffer_load_dwordx4 v12, s[20:23], s56 offen lds
  s_add_u32 m0, s90, 33792
  s_nop 0
  buffer_load_dwordx4 v13, s[20:23], s56 offen lds
  s_add_u32 s56, s93, 0
  s_and_b32 s56, s56, 7
  s_mul_i32 s56, s56, 65536
  s_add_u32 m0, s90, 106496
  s_nop 0
  buffer_load_dwordx4 v17, s[24:27], s56 offen lds
  s_add_u32 m0, s90, 107520
  s_nop 0
  buffer_load_dwordx4 v18, s[24:27], s56 offen lds
  s_waitcnt vmcnt(18)
  s_barrier
  s_add_u32 s56, s93, 0
  s_and_b32 s56, s56, 7
  s_mul_i32 s56, s56, 270336
  s_add_u32 m0, s90, 40960
  s_nop 0
  buffer_load_dwordx4 v21, s[28:31], s56 offen sc1 lds
  s_add_u32 m0, s90, 41984
  s_nop 0
  buffer_load_dwordx4 v22, s[28:31], s56 offen sc1 lds
  s_add_u32 s56, s93, 1
  s_and_b32 s56, s56, 7
  s_mul_i32 s56, s56, 65536
  s_add_u32 m0, s90, 49152
  s_nop 0
  buffer_load_dwordx4 v17, s[24:27], s56 offen lds
  s_add_u32 m0, s90, 50176
  s_nop 0
  buffer_load_dwordx4 v18, s[24:27], s56 offen lds
  s_waitcnt vmcnt(18)
  s_barrier
  s_add_u32 s56, s93, 1
  s_and_b32 s56, s56, 7
  s_mul_i32 s56, s56, 270336
  s_add_u32 m0, s90, 57344
  s_nop 0
  buffer_load_dwordx4 v21, s[28:31], s56 offen sc1 lds
  s_add_u32 m0, s90, 58368
  s_nop 0
  buffer_load_dwordx4 v22, s[28:31], s56 offen sc1 lds
  s_add_u32 s56, s93, 2
  s_and_b32 s56, s56, 7
  s_mul_i32 s56, s56, 65536
  s_add_u32 m0, s90, 114688
  s_nop 0
  buffer_load_dwordx4 v17, s[24:27], s56 offen lds
  s_add_u32 m0, s90, 115712
  s_nop 0
  buffer_load_dwordx4 v18, s[24:27], s56 offen lds
  s_waitcnt vmcnt(18)
  s_barrier
  s_add_u32 s56, s93, 2
  s_and_b32 s56, s56, 7
  s_mul_i32 s56, s56, 270336
  s_add_u32 m0, s90, 16384
  s_nop 0
  buffer_load_dwordx4 v21, s[28:31], s56 offen sc1 lds
  s_add_u32 m0, s90, 17408
  s_nop 0
  buffer_load_dwordx4 v22, s[28:31], s56 offen sc1 lds
  s_add_u32 s56, s93, 3
  s_and_b32 s56, s56, 7
  s_mul_i32 s56, s56, 65536
  s_add_u32 m0, s90, 65536
  s_nop 0
  buffer_load_dwordx4 v17, s[24:27], s56 offen lds
  s_add_u32 m0, s90, 66560
  s_nop 0
  buffer_load_dwordx4 v18, s[24:27], s56 offen lds
  s_waitcnt vmcnt(18)
  s_barrier
  s_add_u32 s56, s93, 3
  s_and_b32 s56, s56, 7
  s_mul_i32 s56, s56, 270336
  s_add_u32 m0, s90, 0
  s_nop 0
  buffer_load_dwordx4 v21, s[28:31], s56 offen sc1 lds
  s_add_u32 m0, s90, 1024
  s_nop 0
  buffer_load_dwordx4 v22, s[28:31], s56 offen sc1 lds
  s_add_u32 s56, s93, 4
  s_and_b32 s56, s56, 7
  s_mul_i32 s56, s56, 65536
  s_add_u32 m0, s90, 73728
  s_nop 0
  buffer_load_dwordx4 v17, s[24:27], s56 offen lds
  s_add_u32 m0, s90, 74752
  s_nop 0
  buffer_load_dwordx4 v18, s[24:27], s56 offen lds
  s_waitcnt vmcnt(18)
  s_barrier
  s_add_u32 s56, s93, 4
  s_and_b32 s56, s56, 7
  s_mul_i32 s56, s56, 270336
  s_add_u32 m0, s90, 24576
  s_nop 0
  buffer_load_dwordx4 v21, s[28:31], s56 offen sc1 lds
  s_add_u32 m0, s90, 25600
  s_nop 0
  buffer_load_dwordx4 v22, s[28:31], s56 offen sc1 lds
  s_add_u32 s56, s93, 5
  s_and_b32 s56, s56, 7
  s_mul_i32 s56, s56, 65536
  s_add_u32 m0, s90, 81920
  s_nop 0
  buffer_load_dwordx4 v17, s[24:27], s56 offen lds
  s_add_u32 m0, s90, 82944
  s_nop 0
  buffer_load_dwordx4 v18, s[24:27], s56 offen lds
  s_barrier
  s_add_u32 s56, s93, 5
  s_and_b32 s56, s56, 7
  s_mul_i32 s56, s56, 270336
  s_add_u32 m0, s90, 8192
  s_nop 0
  buffer_load_dwordx4 v21, s[28:31], s56 offen sc1 lds
  s_add_u32 m0, s90, 9216
  s_nop 0
  buffer_load_dwordx4 v22, s[28:31], s56 offen sc1 lds
  s_add_u32 s56, s93, 6
  s_and_b32 s56, s56, 7
  s_mul_i32 s56, s56, 65536
  s_add_u32 m0, s90, 90112
  s_nop 0
  buffer_load_dwordx4 v17, s[24:27], s56 offen lds
  s_add_u32 m0, s90, 91136
  s_nop 0
  buffer_load_dwordx4 v18, s[24:27], s56 offen lds
  s_add_u32 s56, s93, 6
  s_and_b32 s56, s56, 7
  s_mul_i32 s56, s56, 270336
  s_add_u32 m0, s90, 122880
  s_nop 0
  buffer_load_dwordx4 v21, s[28:31], s56 offen sc1 lds
  s_add_u32 m0, s90, 123904
  s_nop 0
  buffer_load_dwordx4 v22, s[28:31], s56 offen sc1 lds
  s_add_u32 s56, s93, 7
  s_and_b32 s56, s56, 7
  s_mul_i32 s56, s56, 65536
  s_add_u32 m0, s90, 131072
  s_nop 0
  buffer_load_dwordx4 v17, s[24:27], s56 offen lds
  s_add_u32 m0, s90, 132096
  s_nop 0
  buffer_load_dwordx4 v18, s[24:27], s56 offen lds
  s_waitcnt vmcnt(26)
  s_barrier
  s_add_u32 s56, s93, 7
  s_and_b32 s56, s56, 7
  s_mul_i32 s56, s56, 270336
  s_add_u32 m0, s90, 32768
  s_nop 0
  buffer_load_dwordx4 v21, s[28:31], s56 offen sc1 lds
  s_add_u32 m0, s90, 33792
  s_nop 0
  buffer_load_dwordx4 v22, s[28:31], s56 offen sc1 lds
  s_add_u32 s56, s94, 0
  s_sub_u32 s57, s56, 22
  s_cmp_ge_u32 s56, 22
  s_cselect_b32 s56, s57, s56
  s_mul_i32 s56, s56, 262144
  s_add_u32 m0, s90, 98304
  s_nop 0
  buffer_load_dwordx4 v19, s[36:39], s56 offen lds
  s_add_u32 m0, s90, 99328
  s_nop 0
  buffer_load_dwordx4 v20, s[36:39], s56 offen lds
  s_add_u32 s56, s94, 1
  s_sub_u32 s57, s56, 22
  s_cmp_ge_u32 s56, 22
  s_cselect_b32 s56, s57, s56
  s_mul_i32 s56, s56, 262144
  s_add_u32 m0, s90, 139264
  s_nop 0
  buffer_load_dwordx4 v19, s[36:39], s56 offen lds
  s_add_u32 m0, s90, 140288
  s_nop 0
  buffer_load_dwordx4 v20, s[36:39], s56 offen lds
  s_waitcnt vmcnt(28)
  s_barrier
  s_waitcnt vmcnt(24)
  s_barrier
  s_add_u32 s56, s94, 2
  s_sub_u32 s57, s56, 22
  s_cmp_ge_u32 s56, 22
  s_cselect_b32 s56, s57, s56
  s_mul_i32 s56, s56, 262144
  s_add_u32 m0, s90, 40960
  s_nop 0
  buffer_load_dwordx4 v19, s[36:39], s56 offen lds
  s_add_u32 m0, s90, 41984
  s_nop 0
  buffer_load_dwordx4 v20, s[36:39], s56 offen lds
  s_add_u32 s56, s94, 3
  s_sub_u32 s57, s56, 22
  s_cmp_ge_u32 s56, 22
  s_cselect_b32 s56, s57, s56
  s_mul_i32 s56, s56, 262144
  s_add_u32 m0, s90, 106496
  s_nop 0
  buffer_load_dwordx4 v19, s[36:39], s56 offen lds
  s_add_u32 m0, s90, 107520
  s_nop 0
  buffer_load_dwordx4 v20, s[36:39], s56 offen lds
  s_waitcnt vmcnt(24)
  s_barrier
  s_add_u32 s56, s94, 4
  s_sub_u32 s57, s56, 22
  s_cmp_ge_u32 s56, 22
  s_cselect_b32 s56, s57, s56
  s_mul_i32 s56, s56, 262144
  s_add_u32 m0, s90, 49152
  s_nop 0
  buffer_load_dwordx4 v19, s[36:39], s56 offen lds
  s_add_u32 m0, s90, 50176
  s_nop 0
  buffer_load_dwordx4 v20, s[36:39], s56 offen lds
  s_add_u32 s56, s94, 5
  s_sub_u32 s57, s56, 22
  s_cmp_ge_u32 s56, 22
  s_cselect_b32 s56, s57, s56
  s_mul_i32 s56, s56, 262144
  s_add_u32 m0, s90, 57344
  s_nop 0
  buffer_load_dwordx4 v19, s[36:39], s56 offen lds
  s_add_u32 m0, s90, 58368
  s_nop 0
  buffer_load_dwordx4 v20, s[36:39], s56 offen lds
  s_waitcnt vmcnt(24)
  s_barrier
  s_add_u32 s56, s94, 6
  s_sub_u32 s57, s56, 22
  s_cmp_ge_u32 s56, 22
  s_cselect_b32 s56, s57, s56
  s_mul_i32 s56, s56, 262144
  s_add_u32 m0, s90, 16384
  s_nop 0
  buffer_load_dwordx4 v19, s[36:39], s56 offen lds
  s_add_u32 m0, s90, 17408
  s_nop 0
  buffer_load_dwordx4 v20, s[36:39], s56 offen lds
  s_add_u32 s56, s94, 7
  s_sub_u32 s57, s56, 22
  s_cmp_ge_u32 s56, 22
  s_cselect_b32 s56, s57, s56
  s_mul_i32 s56, s56, 262144
  s_add_u32 m0, s90, 114688
  s_nop 0
  buffer_load_dwordx4 v19, s[36:39], s56 offen lds
  s_add_u32 m0, s90, 115712
  s_nop 0
  buffer_load_dwordx4 v20, s[36:39], s56 offen lds
  s_waitcnt vmcnt(24)
  s_barrier
  s_add_u32 s56, s94, 0
  s_sub_u32 s57, s56, 22
  s_cmp_ge_u32 s56, 22
  s_cselect_b32 s56, s57, s56
  s_mul_i32 s56, s56, 73728
  s_add_u32 m0, s90, 0
  s_nop 0
  buffer_load_dwordx4 v23, s[32:35], s56 offen sc1 lds
  s_add_u32 m0, s90, 1024
  s_nop 0
  buffer_load_dwordx4 v24, s[32:35], s56 offen sc1 lds
  s_add_u32 s56, s94, 1
  s_sub_u32 s57, s56, 22
  s_cmp_ge_u32 s56, 22
  s_cselect_b32 s56, s57, s56
  s_mul_i32 s56, s56, 73728
  s_add_u32 m0, s90, 65536
  s_nop 0
  buffer_load_dwordx4 v23, s[32:35], s56 offen sc1 lds
  s_add_u32 m0, s90, 66560
  s_nop 0
  buffer_load_dwordx4 v24, s[32:35], s56 offen sc1 lds
  s_waitcnt vmcnt(24)
  s_barrier
  s_add_u32 s56, s94, 2
  s_sub_u32 s57, s56, 22
  s_cmp_ge_u32 s56, 22
  s_cselect_b32 s56, s57, s56
  s_mul_i32 s56, s56, 73728
  s_add_u32 m0, s90, 24576
  s_nop 0
  buffer_load_dwordx4 v23, s[32:35], s56 offen sc1 lds
  s_add_u32 m0, s90, 25600
  s_nop 0
  buffer_load_dwordx4 v24, s[32:35], s56 offen sc1 lds
  s_add_u32 s56, s94, 3
  s_sub_u32 s57, s56, 22
  s_cmp_ge_u32 s56, 22
  s_cselect_b32 s56, s57, s56
  s_mul_i32 s56, s56, 73728
  s_add_u32 m0, s90, 73728
  s_nop 0
  buffer_load_dwordx4 v23, s[32:35], s56 offen sc1 lds
  s_add_u32 m0, s90, 74752
  s_nop 0
  buffer_load_dwordx4 v24, s[32:35], s56 offen sc1 lds
  s_waitcnt vmcnt(24)
  s_barrier
  s_add_u32 s56, s94, 4
  s_sub_u32 s57, s56, 22
  s_cmp_ge_u32 s56, 22
  s_cselect_b32 s56, s57, s56
  s_mul_i32 s56, s56, 73728
  s_add_u32 m0, s90, 8192
  s_nop 0
  buffer_load_dwordx4 v23, s[32:35], s56 offen sc1 lds
  s_add_u32 m0, s90, 9216
  s_nop 0
  buffer_load_dwordx4 v24, s[32:35], s56 offen sc1 lds
  s_add_u32 s56, s94, 5
  s_sub_u32 s57, s56, 22
  s_cmp_ge_u32 s56, 22
  s_cselect_b32 s56, s57, s56
  s_mul_i32 s56, s56, 73728
  s_add_u32 m0, s90, 81920
  s_nop 0
  buffer_load_dwordx4 v23, s[32:35], s56 offen sc1 lds
  s_add_u32 m0, s90, 82944
  s_nop 0
  buffer_load_dwordx4 v24, s[32:35], s56 offen sc1 lds
  s_waitcnt vmcnt(10)
  s_barrier
  s_add_u32 s56, s94, 6
  s_sub_u32 s57, s56, 22
  s_cmp_ge_u32 s56, 22
  s_cselect_b32 s56, s57, s56
  s_mul_i32 s56, s56, 73728
  s_add_u32 m0, s90, 90112
  s_nop 0
  buffer_load_dwordx4 v23, s[32:35], s56 offen sc1 lds
  s_add_u32 m0, s90, 91136
  s_nop 0
  buffer_load_dwordx4 v24, s[32:35], s56 offen sc1 lds
  s_add_u32 s56, s94, 7
  s_sub_u32 s57, s56, 22
  s_cmp_ge_u32 s56, 22
  s_cselect_b32 s56, s57, s56
  s_mul_i32 s56, s56, 73728
  s_add_u32 m0, s90, 122880
  s_nop 0
  buffer_load_dwordx4 v23, s[32:35], s56 offen sc1 lds
  s_add_u32 m0, s90, 123904
  s_nop 0
  buffer_load_dwordx4 v24, s[32:35], s56 offen sc1 lds
  s_waitcnt vmcnt(12)
  s_barrier
  s_add_u32 s56, s94, 8
  s_sub_u32 s57, s56, 22
  s_cmp_ge_u32 s56, 22
  s_cselect_b32 s56, s57, s56
  s_mul_i32 s56, s56, 73728
  s_add_u32 m0, s90, 32768
  s_nop 0
  buffer_load_dwordx4 v23, s[32:35], s56 offen sc1 lds
  s_add_u32 m0, s90, 33792
  s_nop 0
  buffer_load_dwordx4 v24, s[32:35], s56 offen sc1 lds
  s_add_u32 s56, s94, 8
  s_sub_u32 s57, s56, 22
  s_cmp_ge_u32 s56, 22
  s_cselect_b32 s56, s57, s56
  s_mul_i32 s56, s56, 262144
  s_add_u32 m0, s90, 131072
  s_nop 0
  buffer_load_dwordx4 v19, s[36:39], s56 offen lds
  s_add_u32 m0, s90, 132096
  s_nop 0
  buffer_load_dwordx4 v20, s[36:39], s56 offen lds
  s_waitcnt vmcnt(14)
  s_barrier
  s_add_u32 s56, s94, 9
  s_sub_u32 s57, s56, 22
  s_cmp_ge_u32 s56, 22
  s_cselect_b32 s56, s57, s56
  s_mul_i32 s56, s56, 73728
  s_add_u32 m0, s90, 0
  s_nop 0
  buffer_load_dwordx4 v23, s[32:35], s56 offen sc1 lds
  s_add_u32 m0, s90, 1024
  s_nop 0
  buffer_load_dwordx4 v24, s[32:35], s56 offen sc1 lds
  s_add_u32 s56, s94, 9
  s_sub_u32 s57, s56, 22
  s_cmp_ge_u32 s56, 22
  s_cselect_b32 s56, s57, s56
  s_mul_i32 s56, s56, 262144
  s_add_u32 m0, s90, 98304
  s_nop 0
  buffer_load_dwordx4 v19, s[36:39], s56 offen lds
  s_add_u32 m0, s90, 99328
  s_nop 0
  buffer_load_dwordx4 v20, s[36:39], s56 offen lds
  s_waitcnt vmcnt(16)
  s_barrier
  s_add_u32 s56, s94, 10
  s_sub_u32 s57, s56, 22
  s_cmp_ge_u32 s56, 22
  s_cselect_b32 s56, s57, s56
  s_mul_i32 s56, s56, 73728
  s_add_u32 m0, s90, 65536
  s_nop 0
  buffer_load_dwordx4 v23, s[32:35], s56 offen sc1 lds
  s_add_u32 m0, s90, 66560
  s_nop 0
  buffer_load_dwordx4 v24, s[32:35], s56 offen sc1 lds
  s_add_u32 s56, s94, 10
  s_sub_u32 s57, s56, 22
  s_cmp_ge_u32 s56, 22
  s_cselect_b32 s56, s57, s56
  s_mul_i32 s56, s56, 262144
  s_add_u32 m0, s90, 139264
  s_nop 0
  buffer_load_dwordx4 v19, s[36:39], s56 offen lds
  s_add_u32 m0, s90, 140288
  s_nop 0
  buffer_load_dwordx4 v20, s[36:39], s56 offen lds
  s_waitcnt vmcnt(18)
  s_barrier
  s_add_u32 s56, s94, 11
  s_sub_u32 s57, s56, 22
  s_cmp_ge_u32 s56, 22
  s_cselect_b32 s56, s57, s56
  s_mul_i32 s56, s56, 73728
  s_add_u32 m0, s90, 24576
  s_nop 0
  buffer_load_dwordx4 v23, s[32:35], s56 offen sc1 lds
  s_add_u32 m0, s90, 25600
  s_nop 0
  buffer_load_dwordx4 v24, s[32:35], s56 offen sc1 lds
  s_add_u32 s56, s94, 11
  s_sub_u32 s57, s56, 22
  s_cmp_ge_u32 s56, 22
  s_cselect_b32 s56, s57, s56
  s_mul_i32 s56, s56, 262144
  s_add_u32 m0, s90, 40960
  s_nop 0
  buffer_load_dwordx4 v19, s[36:39], s56 offen lds
  s_add_u32 m0, s90, 41984
  s_nop 0
  buffer_load_dwordx4 v20, s[36:39], s56 offen lds
  s_waitcnt vmcnt(20)
  s_barrier
  s_add_u32 s56, s94, 12
  s_sub_u32 s57, s56, 22
  s_cmp_ge_u32 s56, 22
  s_cselect_b32 s56, s57, s56
  s_mul_i32 s56, s56, 73728
  s_add_u32 m0, s90, 73728
  s_nop 0
  buffer_load_dwordx4 v23, s[32:35], s56 offen sc1 lds
  s_add_u32 m0, s90, 74752
  s_nop 0
  buffer_load_dwordx4 v24, s[32:35], s56 offen sc1 lds
  s_add_u32 s56, s94, 12
  s_sub_u32 s57, s56, 22
  s_cmp_ge_u32 s56, 22
  s_cselect_b32 s56, s57, s56
  s_mul_i32 s56, s56, 262144
  s_add_u32 m0, s90, 106496
  s_nop 0
  buffer_load_dwordx4 v19, s[36:39], s56 offen lds
  s_add_u32 m0, s90, 107520
  s_nop 0
  buffer_load_dwordx4 v20, s[36:39], s56 offen lds
  s_waitcnt vmcnt(22)
  s_barrier
  s_add_u32 s56, s94, 13
  s_sub_u32 s57, s56, 22
  s_cmp_ge_u32 s56, 22
  s_cselect_b32 s56, s57, s56
  s_mul_i32 s56, s56, 73728
  s_add_u32 m0, s90, 8192
  s_nop 0
  buffer_load_dwordx4 v23, s[32:35], s56 offen sc1 lds
  s_add_u32 m0, s90, 9216
  s_nop 0
  buffer_load_dwordx4 v24, s[32:35], s56 offen sc1 lds
  s_add_u32 s56, s94, 13
  s_sub_u32 s57, s56, 22
  s_cmp_ge_u32 s56, 22
  s_cselect_b32 s56, s57, s56
  s_mul_i32 s56, s56, 262144
  s_add_u32 m0, s90, 49152
  s_nop 0
  buffer_load_dwordx4 v19, s[36:39], s56 offen lds
  s_add_u32 m0, s90, 50176
  s_nop 0
  buffer_load_dwordx4 v20, s[36:39], s56 offen lds
  s_waitcnt vmcnt(24)
  s_barrier
  s_add_u32 s56, s94, 14
  s_sub_u32 s57, s56, 22
  s_cmp_ge_u32 s56, 22
  s_cselect_b32 s56, s57, s56
  s_mul_i32 s56, s56, 73728
  s_add_u32 m0, s90, 57344
  s_nop 0
  buffer_load_dwordx4 v23, s[32:35], s56 offen sc1 lds
  s_add_u32 m0, s90, 58368
  s_nop 0
  buffer_load_dwordx4 v24, s[32:35], s56 offen sc1 lds
  s_add_u32 s56, s94, 14
  s_sub_u32 s57, s56, 22
  s_cmp_ge_u32 s56, 22
  s_cselect_b32 s56, s57, s56
  s_mul_i32 s56, s56, 262144
  s_add_u32 m0, s90, 81920
  s_nop 0
  buffer_load_dwordx4 v19, s[36:39], s56 offen lds
  s_add_u32 m0, s90, 82944
  s_nop 0
  buffer_load_dwordx4 v20, s[36:39], s56 offen lds
  s_waitcnt vmcnt(24)
  s_barrier
  s_add_u32 s56, s94, 15
  s_sub_u32 s57, s56, 22
  s_cmp_ge_u32 s56, 22
  s_cselect_b32 s56, s57, s56
  s_mul_i32 s56, s56, 73728
  s_add_u32 m0, s90, 16384
  s_nop 0
  buffer_load_dwordx4 v23, s[32:35], s56 offen sc1 lds
  s_add_u32 m0, s90, 17408
  s_nop 0
  buffer_load_dwordx4 v24, s[32:35], s56 offen sc1 lds
  s_add_u32 s56, s94, 15
  s_sub_u32 s57, s56, 22
  s_cmp_ge_u32 s56, 22
  s_cselect_b32 s56, s57, s56
  s_mul_i32 s56, s56, 262144
  s_add_u32 m0, s90, 90112
  s_nop 0
  buffer_load_dwordx4 v19, s[36:39], s56 offen lds
  s_add_u32 m0, s90, 91136
  s_nop 0
  buffer_load_dwordx4 v20, s[36:39], s56 offen lds
  s_waitcnt vmcnt(24)
  s_barrier
  s_add_u32 s56, s94, 16
  s_sub_u32 s57, s56, 22
  s_cmp_ge_u32 s56, 22
  s_cselect_b32 s56, s57, s56
  s_mul_i32 s56, s56, 73728
  s_add_u32 m0, s90, 114688
  s_nop 0
  buffer_load_dwordx4 v23, s[32:35], s56 offen sc1 lds
  s_add_u32 m0, s90, 115712
  s_nop 0
  buffer_load_dwordx4 v24, s[32:35], s56 offen sc1 lds
  s_add_u32 s56, s94, 16
  s_sub_u32 s57, s56, 22
  s_cmp_ge_u32 s56, 22
  s_cselect_b32 s56, s57, s56
  s_mul_i32 s56, s56, 262144
  s_add_u32 m0, s90, 122880
  s_nop 0
  buffer_load_dwordx4 v19, s[36:39], s56 offen lds
  s_add_u32 m0, s90, 123904
  s_nop 0
  buffer_load_dwordx4 v20, s[36:39], s56 offen lds
  s_waitcnt vmcnt(24)
  s_barrier
  s_add_u32 s56, s94, 17
  s_sub_u32 s57, s56, 22
  s_cmp_ge_u32 s56, 22
  s_cselect_b32 s56, s57, s56
  s_mul_i32 s56, s56, 73728
  s_add_u32 m0, s90, 32768
  s_nop 0
  buffer_load_dwordx4 v23, s[32:35], s56 offen sc1 lds
  s_add_u32 m0, s90, 33792
  s_nop 0
  buffer_load_dwordx4 v24, s[32:35], s56 offen sc1 lds
  s_add_u32 s56, s94, 17
  s_sub_u32 s57, s56, 22
  s_cmp_ge_u32 s56, 22
  s_cselect_b32 s56, s57, s56
  s_mul_i32 s56, s56, 262144
  s_add_u32 m0, s90, 131072
  s_nop 0
  buffer_load_dwordx4 v19, s[36:39], s56 offen lds
  s_add_u32 m0, s90, 132096
  s_nop 0
  buffer_load_dwordx4 v20, s[36:39], s56 offen lds
  s_waitcnt vmcnt(24)
  s_barrier
  s_add_u32 s56, s94, 18
  s_sub_u32 s57, s56, 22
  s_cmp_ge_u32 s56, 22
  s_cselect_b32 s56, s57, s56
  s_mul_i32 s56, s56, 73728
  s_add_u32 m0, s90, 0
  s_nop 0
  buffer_load_dwordx4 v23, s[32:35], s56 offen sc1 lds
  s_add_u32 m0, s90, 1024
  s_nop 0
  buffer_load_dwordx4 v24, s[32:35], s56 offen sc1 lds
  s_add_u32 s56, s94, 18
  s_sub_u32 s57, s56, 22
  s_cmp_ge_u32 s56, 22
  s_cselect_b32 s56, s57, s56
  s_mul_i32 s56, s56, 262144
  s_add_u32 m0, s90, 98304
  s_nop 0
  buffer_load_dwordx4 v19, s[36:39], s56 offen lds
  s_add_u32 m0, s90, 99328
  s_nop 0
  buffer_load_dwordx4 v20, s[36:39], s56 offen lds
  s_waitcnt vmcnt(24)
  s_barrier
  s_add_u32 s56, s94, 19
  s_sub_u32 s57, s56, 22
  s_cmp_ge_u32 s56, 22
  s_cselect_b32 s56, s57, s56
  s_mul_i32 s56, s56, 73728
  s_add_u32 m0, s90, 65536
  s_nop 0
  buffer_load_dwordx4 v23, s[32:35], s56 offen sc1 lds
  s_add_u32 m0, s90, 66560
  s_nop 0
  buffer_load_dwordx4 v24, s[32:35], s56 offen sc1 lds
  s_add_u32 s56, s94, 19
  s_sub_u32 s57, s56, 22
  s_cmp_ge_u32 s56, 22
  s_cselect_b32 s56, s57, s56
  s_mul_i32 s56, s56, 262144
  s_add_u32 m0, s90, 139264
  s_nop 0
  buffer_load_dwordx4 v19, s[36:39], s56 offen lds
  s_add_u32 m0, s90, 140288
  s_nop 0
  buffer_load_dwordx4 v20, s[36:39], s56 offen lds
  s_waitcnt vmcnt(24)
  s_barrier
  s_add_u32 s56, s94, 20
  s_sub_u32 s57, s56, 22
  s_cmp_ge_u32 s56, 22
  s_cselect_b32 s56, s57, s56
  s_mul_i32 s56, s56, 73728
  s_add_u32 m0, s90, 24576
  s_nop 0
  buffer_load_dwordx4 v23, s[32:35], s56 offen sc1 lds
  s_add_u32 m0, s90, 25600
  s_nop 0
  buffer_load_dwordx4 v24, s[32:35], s56 offen sc1 lds
  s_add_u32 s56, s94, 20
  s_sub_u32 s57, s56, 22
  s_cmp_ge_u32 s56, 22
  s_cselect_b32 s56, s57, s56
  s_mul_i32 s56, s56, 262144
  s_add_u32 m0, s90, 40960
  s_nop 0
  buffer_load_dwordx4 v19, s[36:39], s56 offen lds
  s_add_u32 m0, s90, 41984
  s_nop 0
  buffer_load_dwordx4 v20, s[36:39], s56 offen lds
  s_waitcnt vmcnt(24)
  s_barrier
  s_add_u32 s56, s94, 21
  s_sub_u32 s57, s56, 22
  s_cmp_ge_u32 s56, 22
  s_cselect_b32 s56, s57, s56
  s_mul_i32 s56, s56, 73728
  s_add_u32 m0, s90, 73728
  s_nop 0
  buffer_load_dwordx4 v23, s[32:35], s56 offen sc1 lds
  s_add_u32 m0, s90, 74752
  s_nop 0
  buffer_load_dwordx4 v24, s[32:35], s56 offen sc1 lds
  s_add_u32 s56, s94, 21
  s_sub_u32 s57, s56, 22
  s_cmp_ge_u32 s56, 22
  s_cselect_b32 s56, s57, s56
  s_mul_i32 s56, s56, 262144
  s_add_u32 m0, s90, 106496
  s_nop 0
  buffer_load_dwordx4 v19, s[36:39], s56 offen lds
  s_add_u32 m0, s90, 107520
  s_nop 0
  buffer_load_dwordx4 v20, s[36:39], s56 offen lds
  s_waitcnt vmcnt(24)
  s_barrier
  s_waitcnt vmcnt(20)
  s_barrier
  s_waitcnt vmcnt(16)
  s_barrier
  s_waitcnt vmcnt(12)
  s_barrier
  s_waitcnt vmcnt(8)
  s_barrier
  s_waitcnt vmcnt(4)
  s_barrier
  s_waitcnt vmcnt(0)
  s_barrier
  s_barrier
  s_endpgm
K_end:
  s_endpgm
.section .rodata,"a"
.p2align 6
.amdhsa_kernel parallel_sum__sliding_local_dilated__mixer_token_mlp__prompt_kernel
  .amdhsa_next_free_vgpr 256
  .amdhsa_next_free_sgpr 102
  .amdhsa_accum_offset 256
  .amdhsa_group_segment_fixed_size 0
  .amdhsa_kernarg_size 88
  .amdhsa_user_sgpr_count 2
  .amdhsa_user_sgpr_kernarg_segment_ptr 1
  .amdhsa_system_sgpr_workgroup_id_x 1
  .amdhsa_float_denorm_mode_32 3
.end_amdhsa_kernel
```
